```python
import torch

def _softmax(x, axis=-1):
    return torch.softmax(x, dim=axis)
def _gelu(x):
    return torch.nn.functional.gelu(x, approximate="tanh")
def _silu(x):
    return torch.nn.functional.silu(x)
def _sigmoid(x):
    return torch.sigmoid(x)
def _layernorm(x, axis=-1, eps=1e-5):
    m = x.mean(dim=axis, keepdim=True)
    v = x.var(dim=axis, keepdim=True, unbiased=False)
    return (x - m) / torch.sqrt(v + eps)
def _scatter_add(tgt, idx, src, axis=0):
    return tgt.clone().index_add_(axis, idx, src)
def _segment_sum(src, seg, n):
    out = torch.zeros((n,) + src.shape[1:], dtype=src.dtype)
    return out.index_add_(0, seg, src)
def _pad(x, pw):
    flat = tuple(v for pair in reversed(pw) for v in pair)
    return torch.nn.functional.pad(x, flat)

kernel_name = 'recurrent_scan__spectral_fnet__glu_gated_glu__prompt'

def setup_inputs():

    _w = (lambda a: (lambda t: t.to(torch.bfloat16) if t.is_floating_point() else t)(torch.as_tensor(a)))
    def _A_setup():
        B, S, D = 1, 2048, 512
        ns = torch.arange(S)[:, None] * torch.arange(S)[None, :]
        nd = torch.arange(D)[:, None] * torch.arange(D)[None, :]
        Ws_re = torch.cos(-2.0 * torch.pi * ns / S).to(float)
        Ws_im = torch.sin(-2.0 * torch.pi * ns / S).to(float)
        Wd_re = torch.cos(-2.0 * torch.pi * nd / D).to(float)
        Wd_im = torch.sin(-2.0 * torch.pi * nd / D).to(float)
        return {
            "x": _w((lambda *s: torch.randn(*s, dtype=torch.bfloat16) * 0.05)(B, S, D)),
            "dft_seq_re": _w(Ws_re),
            "dft_seq_im": _w(Ws_im),
            "dft_hid_re": _w(Wd_re),
            "dft_hid_im": _w(Wd_im),
        }
    _A_in = _A_setup()

    def _B_setup():
        B, S, D, F = 1, 2048, 512, 1792
        return {
            "x": _w((lambda *s: torch.randn(*s, dtype=torch.bfloat16) * 0.05)(B, S, D)),
            "w_gate": _w((lambda *s: torch.randn(*s, dtype=torch.bfloat16) * 0.05)(D, F)),
            "w_up": _w((lambda *s: torch.randn(*s, dtype=torch.bfloat16) * 0.05)(D, F)),
            "w_down": _w((lambda *s: torch.randn(*s, dtype=torch.bfloat16) * 0.05)(F, D)),
        }
    _B_in = _B_setup()

    return {
        "A_x": _A_in["x"],
        "A_dft_seq_re": _A_in["dft_seq_re"],
        "A_dft_seq_im": _A_in["dft_seq_im"],
        "A_dft_hid_re": _A_in["dft_hid_re"],
        "A_dft_hid_im": _A_in["dft_hid_im"],
        "B_x": _B_in["x"],
        "B_w_gate": _B_in["w_gate"],
        "B_w_up": _B_in["w_up"],
        "B_w_down": _B_in["w_down"],
    }

def reference(A_x, A_dft_seq_re, A_dft_seq_im, A_dft_hid_re, A_dft_hid_im, B_x, B_w_gate, B_w_up, B_w_down):
    def _A_ref(x, dft_seq_re, dft_seq_im, dft_hid_re, dft_hid_im):
        a = torch.einsum("bsd,ed->bse", x, dft_hid_re)
        b = torch.einsum("bsd,ed->bse", x, dft_hid_im)
        y = torch.einsum("ts,bse->bte", dft_seq_re, a) - torch.einsum("ts,bse->bte", dft_seq_im, b)
        return y

    def _B_ref(x, w_gate, w_up, w_down):
        g = torch.einsum("bsd,df->bsf", x, w_gate)
        u = torch.einsum("bsd,df->bsf", x, w_up)
        h = _sigmoid(g) * u
        return torch.einsum("bsf,fd->bsd", h, w_down)

    x = A_x
    xn = _layernorm(x, axis=-1)
    s = _A_ref(xn, A_dft_seq_re, A_dft_seq_im, A_dft_hid_re, A_dft_hid_im)
    g = _silu(_B_ref(xn, B_w_gate, B_w_up, B_w_down))
    return x + s * g
```

```asm
; @launch grid=(256,1,1) block=(512,1,1) lds=163840
.amdgcn_target "amdgcn-amd-amdhsa--gfx950"
.text
.globl recurrent_scan__spectral_fnet__glu_gated_glu__prompt_kernel
.p2align 12
.p2align 8
.type recurrent_scan__spectral_fnet__glu_gated_glu__prompt_kernel,@function
recurrent_scan__spectral_fnet__glu_gated_glu__prompt_kernel:
    s_cmp_ge_u32 s2, 256
    s_cbranch_scc1 END
    s_load_dwordx2 s[4:5], s[0:1], 0
    s_load_dwordx4 s[48:51], s[0:1], 24
    s_load_dwordx8 s[52:59], s[0:1], 48
    s_load_dwordx4 s[60:63], s[0:1], 80
    v_lshrrev_b32 v1, 6, v0
    v_and_b32 v0, 63, v0
    s_lshr_b32 s45, s2, 3
    v_readfirstlane_b32 s36, v1
    s_getpc_b64 s[64:65]
PCREF:
    s_cmp_ge_u32 s36, 4
    s_cbranch_scc1 LSTART
    s_lshl_b32 s66, s45, 2
    s_add_u32 s66, s66, s36
    s_mul_i32 s66, s66, 384
    s_min_u32 s66, s66, END-PCREF-384
    s_and_b32 s64, s64, 0xffffff80
    s_load_dwordx2 s[68:69], s[64:65], s66 offset:60
    s_load_dwordx2 s[70:71], s[64:65], s66 offset:188
    s_load_dwordx2 s[72:73], s[64:65], s66 offset:316
    s_branch CWAVE
LSTART:
    s_and_b32 s64, s2, 1
    s_lshl_b32 s64, s64, 3
    s_and_b32 s65, s45, 7
    s_add_u32 s37, s64, s65
    s_bfe_u32 s64, s2, 0x20001
    s_lshr_b32 s67, s45, 3
    s_mul_i32 s65, s64, 3
    s_add_u32 s65, s65, s67
    s_add_u32 s66, s64, 14
    s_cmp_eq_u32 s67, 3
    s_cselect_b32 s65, s66, s65
    s_lshl_b32 s66, s64, 2
    s_add_u32 s66, s66, s67
    s_sub_u32 s66, s66, 2
    s_cmp_lt_u32 s64, 2
    s_cselect_b32 s38, s65, s66
    s_lshl_b32 s42, s38, 8
    s_sub_u32 s64, s42, 3584
    s_movk_i32 s41, 3584
    s_cmp_ge_u32 s38, 14
    s_cselect_b32 s43, 1, 0
    s_cselect_b32 s41, 1024, s41
    s_cselect_b32 s42, s64, s42
    s_lshl_b32 s34, s41, 9
    s_mov_b32 s35, 0x20000
    s_mov_b32 s6, 0x200000
    s_mov_b32 s7, 0x20000
    s_cmp_eq_u32 s36, 6
    s_cbranch_scc1 L2WAVE
    s_cmp_eq_u32 s36, 7
    s_cbranch_scc1 L3WAVE
    s_branch L01WAVE
L2WAVE:
    v_lshrrev_b32 v18, 3, v0
    v_and_b32 v19, 7, v0
    v_mul_lo_u32 v8, v18, s41
    v_lshl_add_u32 v8, v19, 4, v8
    s_lshr_b32 s64, s37, 2
    s_lshl_b32 s64, s64, 4
    s_mul_i32 s69, s64, s41
    s_and_b32 s64, s37, 1
    s_lshl_b32 s64, s64, 7
    s_add_u32 s69, s69, s64
    s_add_u32 s69, s69, s42
    s_lshl_b32 s70, s41, 3
    s_mul_i32 s72, s41, 56
    s_waitcnt lgkmcnt(0)
    s_cmp_eq_u32 s43, 1
    s_cselect_b64 s[8:9], s[48:49], s[52:53]
    s_cselect_b64 s[12:13], s[50:51], s[54:55]
    s_bitcmp1_b32 s37, 1
    s_cselect_b64 s[32:33], s[12:13], s[8:9]
    buffer_load_dwordx4 v[32:35], v8, s[32:35], s69 offen
    s_add_u32 s69, s69, s70
    buffer_load_dwordx4 v[36:39], v8, s[32:35], s69 offen
    s_add_u32 s69, s69, s72
    buffer_load_dwordx4 v[40:43], v8, s[32:35], s69 offen
    s_add_u32 s69, s69, s70
    buffer_load_dwordx4 v[44:47], v8, s[32:35], s69 offen
    s_add_u32 s69, s69, s72
    s_branch L2REST
L3WAVE:
    s_bfe_u32 s64, s38, 0x10002
    s_bfe_u32 s65, s38, 0x10003
    s_lshl_b32 s65, s65, 5
    s_lshl_b32 s66, s37, 1
    s_add_u32 s64, s64, s65
    s_add_u32 s64, s64, s66
    s_and_b32 s65, s38, 3
    s_lshl_b32 s65, s65, 9
    s_add_u32 s64, s64, s65
    s_lshl_b32 s64, s64, 10
    v_lshrrev_b32 v4, 3, v0
    v_and_b32 v14, 7, v0
    v_lshlrev_b32 v6, 16, v4
    v_lshl_add_u32 v6, v14, 4, v6
    s_memrealtime s[66:67]
    s_waitcnt lgkmcnt(0)
    buffer_load_dwordx4 v[16:19], v6, s[4:7], s64 offen offset:0
    buffer_load_dwordx4 v[20:23], v6, s[4:7], s64 offen offset:128
    s_branch L3REST
L01WAVE:
    s_sub_u32 s64, s36, 4
    v_lshrrev_b32 v6, 3, v0
    v_lshlrev_b32 v2, 16, v6
    v_lshrrev_b32 v6, 1, v6
    v_and_b32 v7, 7, v0
    v_xor_b32 v6, v6, v7
    v_lshl_add_u32 v2, v6, 4, v2
    v_xor_b32 v3, 64, v2
    v_lshrrev_b32 v6, 4, v0
    v_mul_lo_u32 v4, v6, s41
    v_bfe_u32 v7, v0, 2, 2
    v_xor_b32 v7, v7, v6
    v_lshlrev_b32 v7, 2, v7
    v_and_b32 v8, 3, v0
    v_or_b32 v7, v7, v8
    v_lshl_add_u32 v4, v7, 4, v4
    v_xor_b32 v7, 2, v7
    v_mul_lo_u32 v12, v6, s41
    v_lshl_add_u32 v12, v7, 4, v12
    s_lshl_b32 s65, s37, 1
    s_add_u32 s65, s65, s64
    s_lshl_b32 s65, s65, 10
    s_add_u32 s66, s65, 32768
    s_mov_b32 s67, s42
    s_lshl_b32 s70, s41, 2
    s_lshl_b32 s74, s64, 10
    s_lshl_b32 s77, s64, 12
    s_mov_b32 s68, 49152
    s_mov_b32 s69, 98304
    s_waitcnt lgkmcnt(0)
    s_add_u32 s71, s68, s77
    s_add_u32 m0, s71, 32768
    s_mov_b32 s71, s65
    buffer_load_dwordx4 v2, s[4:7], s71 offen lds
    s_add_u32 m0, m0, 1024
    s_add_u32 s71, s71, 0x80000
    buffer_load_dwordx4 v3, s[4:7], s71 offen lds
    s_add_u32 m0, m0, 1024
    s_add_u32 s71, s71, 0x80000
    buffer_load_dwordx4 v2, s[4:7], s71 offen lds
    s_add_u32 m0, m0, 1024
    s_add_u32 s71, s71, 0x80000
    buffer_load_dwordx4 v3, s[4:7], s71 offen lds
    s_add_u32 s65, s65, 128
    s_cmp_eq_u32 s43, 1
    s_cselect_b64 s[8:9], s[48:49], s[52:53]
    s_cselect_b64 s[12:13], s[50:51], s[54:55]
    s_cmp_eq_u32 s64, 1
    s_cselect_b64 s[32:33], s[12:13], s[8:9]
    s_add_u32 s71, s68, s74
    s_add_u32 m0, s71, 0
    s_nop 0
    buffer_load_dwordx4 v4, s[32:35], s67 offen lds
    s_add_u32 m0, m0, 2048
    s_add_u32 s67, s67, s70
    buffer_load_dwordx4 v4, s[32:35], s67 offen lds
    s_add_u32 m0, m0, 2048
    s_add_u32 s67, s67, s70
    buffer_load_dwordx4 v12, s[32:35], s67 offen lds
    s_add_u32 m0, m0, 2048
    s_add_u32 s67, s67, s70
    buffer_load_dwordx4 v12, s[32:35], s67 offen lds
    s_add_u32 m0, m0, 2048
    s_add_u32 s67, s67, s70
    buffer_load_dwordx4 v4, s[32:35], s67 offen lds
    s_add_u32 m0, m0, 2048
    s_add_u32 s67, s67, s70
    buffer_load_dwordx4 v4, s[32:35], s67 offen lds
    s_add_u32 m0, m0, 2048
    s_add_u32 s67, s67, s70
    buffer_load_dwordx4 v12, s[32:35], s67 offen lds
    s_add_u32 m0, m0, 2048
    s_add_u32 s67, s67, s70
    buffer_load_dwordx4 v12, s[32:35], s67 offen lds
    s_add_u32 s67, s67, s70
    s_add_u32 s71, s68, s77
    s_add_u32 m0, s71, 40960
    s_mov_b32 s71, s66
    buffer_load_dwordx4 v2, s[4:7], s71 offen lds
    s_add_u32 m0, m0, 1024
    s_add_u32 s71, s71, 0x80000
    buffer_load_dwordx4 v3, s[4:7], s71 offen lds
    s_add_u32 m0, m0, 1024
    s_add_u32 s71, s71, 0x80000
    buffer_load_dwordx4 v2, s[4:7], s71 offen lds
    s_add_u32 m0, m0, 1024
    s_add_u32 s71, s71, 0x80000
    buffer_load_dwordx4 v3, s[4:7], s71 offen lds
    s_add_u32 s66, s66, 128
    s_add_u32 s71, s68, s74
    s_add_u32 m0, s71, 16384
    s_nop 0
    buffer_load_dwordx4 v4, s[32:35], s67 offen lds
    s_add_u32 m0, m0, 2048
    s_add_u32 s67, s67, s70
    buffer_load_dwordx4 v4, s[32:35], s67 offen lds
    s_add_u32 m0, m0, 2048
    s_add_u32 s67, s67, s70
    buffer_load_dwordx4 v12, s[32:35], s67 offen lds
    s_add_u32 m0, m0, 2048
    s_add_u32 s67, s67, s70
    buffer_load_dwordx4 v12, s[32:35], s67 offen lds
    s_add_u32 m0, m0, 2048
    s_add_u32 s67, s67, s70
    buffer_load_dwordx4 v4, s[32:35], s67 offen lds
    s_add_u32 m0, m0, 2048
    s_add_u32 s67, s67, s70
    buffer_load_dwordx4 v4, s[32:35], s67 offen lds
    s_add_u32 m0, m0, 2048
    s_add_u32 s67, s67, s70
    buffer_load_dwordx4 v12, s[32:35], s67 offen lds
    s_add_u32 m0, m0, 2048
    s_add_u32 s67, s67, s70
    buffer_load_dwordx4 v12, s[32:35], s67 offen lds
    s_add_u32 s67, s67, s70
    s_add_u32 s71, s69, s77
    s_add_u32 m0, s71, 32768
    s_mov_b32 s71, s65
    buffer_load_dwordx4 v2, s[4:7], s71 offen lds
    s_add_u32 m0, m0, 1024
    s_add_u32 s71, s71, 0x80000
    buffer_load_dwordx4 v3, s[4:7], s71 offen lds
    s_add_u32 m0, m0, 1024
    s_add_u32 s71, s71, 0x80000
    buffer_load_dwordx4 v2, s[4:7], s71 offen lds
    s_add_u32 m0, m0, 1024
    s_add_u32 s71, s71, 0x80000
    buffer_load_dwordx4 v3, s[4:7], s71 offen lds
    s_add_u32 s65, s65, 128
    s_mov_b64 s[16:17], s[56:57]
    s_mov_b32 s18, 1835008
    s_mov_b32 s19, 0x20000
    s_mov_b64 s[20:21], s[62:63]
    s_mov_b32 s22, 11534336
    s_mov_b32 s23, 0x20000
    s_mov_b64 s[24:25], s[58:59]
    s_mov_b32 s26, 0x200000
    s_mov_b32 s27, 0x20000
    s_mov_b64 s[28:29], s[60:61]
    s_mov_b32 s30, 256
    s_mov_b32 s31, 0x20000
    s_lshr_b32 s60, s45, 2
    s_lshl_b32 s60, s60, 10
    s_and_b32 s63, s45, 3
    s_lshl_b32 s63, s63, 7
    s_add_u32 s60, s60, s63
    s_and_b32 s63, s2, 1
    s_lshl_b32 s63, s63, 9
    s_add_u32 s60, s60, s63
    s_bfe_u32 s63, s2, 0x20001
    s_mul_i32 s62, s63, 458752
    s_add_u32 s60, s60, s62
    s_sub_u32 s63, s36, 4
    s_mul_i32 s63, s63, 229376
    s_add_u32 s60, s60, s63
    s_mov_b32 s46, s2
    s_bfe_u32 s47, s46, 0x20001
    s_lshl_b32 s47, s47, 3
    s_and_b32 s39, s45, 7
    s_add_u32 s39, s39, s47
    s_and_b32 s46, s46, 1
    s_lshl_b32 s46, s46, 2
    s_lshr_b32 s40, s45, 3
    s_add_u32 s40, s40, s46
    s_lshr_b32 s61, s39, 1
    s_lshl_b32 s61, s61, 11
    s_and_b32 s48, s39, 1
    s_lshl_b32 s48, s48, 9
    s_add_u32 s48, s48, s61
    s_add_u32 s48, s48, s74
    s_add_u32 s48, s48, 10485760
    s_add_u32 s61, s61, 10813440
    s_cmp_eq_u32 s64, 0
    s_cselect_b32 s61, s61, 0x40000000
    v_lshrrev_b32 v6, 3, v0
    v_lshlrev_b32 v5, 10, v6
    v_bfe_u32 v6, v0, 4, 1
    v_lshlrev_b32 v6, 2, v6
    v_and_b32 v7, 7, v0
    v_xor_b32 v6, v6, v7
    v_lshl_add_u32 v5, v6, 4, v5
    v_min_u32 v10, 13, v0
    v_lshlrev_b32 v10, 7, v10
    v_and_b32 v47, 31, v0
    s_lshl_b32 s63, s64, 7
    s_add_u32 s63, s63, 150784
    v_lshl_add_u32 v48, v47, 2, s63
    v_lshlrev_b32 v47, 4, v47
    v_mov_b32 v49, 0
    v_lshlrev_b32 v13, 4, v0
    s_lshl_b32 s56, s38, 13
    s_add_u32 s56, s56, s74
    s_add_u32 s56, s56, 10551296
    s_add_u32 s57, s56, 4096
    s_lshl_b32 s62, s37, 11
    s_add_u32 s62, s62, s74
    s_add_u32 s62, s62, 10485760
    s_lshl_b32 s63, s64, 9
    s_add_u32 s63, s63, 147456
    v_lshl_add_u32 v45, v0, 3, s63
    s_lshl_b32 s63, s64, 8
    s_add_u32 s63, s63, 149504
    v_lshl_add_u32 v46, v0, 2, s63
    s_mov_b32 s68, 98304
    s_mov_b32 s69, 0
    s_mov_b32 s72, 6
    s_waitcnt vmcnt(12)
    s_barrier
L01LOOP:
    s_add_u32 s71, s68, s74
    s_add_u32 m0, s71, 0
    s_nop 0
    buffer_load_dwordx4 v4, s[32:35], s67 offen lds
    s_add_u32 m0, m0, 2048
    s_add_u32 s67, s67, s70
    buffer_load_dwordx4 v4, s[32:35], s67 offen lds
    s_add_u32 m0, m0, 2048
    s_add_u32 s67, s67, s70
    buffer_load_dwordx4 v12, s[32:35], s67 offen lds
    s_add_u32 m0, m0, 2048
    s_add_u32 s67, s67, s70
    buffer_load_dwordx4 v12, s[32:35], s67 offen lds
    s_add_u32 m0, m0, 2048
    s_add_u32 s67, s67, s70
    buffer_load_dwordx4 v4, s[32:35], s67 offen lds
    s_add_u32 m0, m0, 2048
    s_add_u32 s67, s67, s70
    buffer_load_dwordx4 v4, s[32:35], s67 offen lds
    s_add_u32 m0, m0, 2048
    s_add_u32 s67, s67, s70
    buffer_load_dwordx4 v12, s[32:35], s67 offen lds
    s_add_u32 m0, m0, 2048
    s_add_u32 s67, s67, s70
    buffer_load_dwordx4 v12, s[32:35], s67 offen lds
    s_add_u32 s67, s67, s70
    s_add_u32 s71, s68, s77
    s_add_u32 m0, s71, 40960
    s_mov_b32 s71, s66
    buffer_load_dwordx4 v2, s[4:7], s71 offen lds
    s_add_u32 m0, m0, 1024
    s_add_u32 s71, s71, 0x80000
    buffer_load_dwordx4 v3, s[4:7], s71 offen lds
    s_add_u32 m0, m0, 1024
    s_add_u32 s71, s71, 0x80000
    buffer_load_dwordx4 v2, s[4:7], s71 offen lds
    s_add_u32 m0, m0, 1024
    s_add_u32 s71, s71, 0x80000
    buffer_load_dwordx4 v3, s[4:7], s71 offen lds
    s_add_u32 s66, s66, 128
    s_sub_u32 s63, 3, s72
    s_cmp_ge_u32 s63, 3
    s_cbranch_scc1 L01X0
    s_buffer_load_dwordx2 s[58:59], s[16:19], s60 offset:60
    s_buffer_load_dwordx2 s[58:59], s[16:19], s60 offset:8252
    s_buffer_load_dwordx2 s[58:59], s[16:19], s60 offset:16444
    s_buffer_load_dwordx2 s[58:59], s[16:19], s60 offset:24636
    s_add_u32 s60, s60, 32768
L01X0:
    s_waitcnt vmcnt(12)
    s_barrier
    s_add_u32 s71, s68, s74
    s_add_u32 m0, s71, 16384
    s_nop 0
    buffer_load_dwordx4 v4, s[32:35], s67 offen lds
    s_add_u32 m0, m0, 2048
    s_add_u32 s67, s67, s70
    buffer_load_dwordx4 v4, s[32:35], s67 offen lds
    s_add_u32 m0, m0, 2048
    s_add_u32 s67, s67, s70
    buffer_load_dwordx4 v12, s[32:35], s67 offen lds
    s_add_u32 m0, m0, 2048
    s_add_u32 s67, s67, s70
    buffer_load_dwordx4 v12, s[32:35], s67 offen lds
    s_add_u32 m0, m0, 2048
    s_add_u32 s67, s67, s70
    buffer_load_dwordx4 v4, s[32:35], s67 offen lds
    s_add_u32 m0, m0, 2048
    s_add_u32 s67, s67, s70
    buffer_load_dwordx4 v4, s[32:35], s67 offen lds
    s_add_u32 m0, m0, 2048
    s_add_u32 s67, s67, s70
    buffer_load_dwordx4 v12, s[32:35], s67 offen lds
    s_add_u32 m0, m0, 2048
    s_add_u32 s67, s67, s70
    buffer_load_dwordx4 v12, s[32:35], s67 offen lds
    s_add_u32 s67, s67, s70
    s_add_u32 s71, s69, s77
    s_add_u32 m0, s71, 32768
    s_mov_b32 s71, s65
    buffer_load_dwordx4 v2, s[4:7], s71 offen lds
    s_add_u32 m0, m0, 1024
    s_add_u32 s71, s71, 0x80000
    buffer_load_dwordx4 v3, s[4:7], s71 offen lds
    s_add_u32 m0, m0, 1024
    s_add_u32 s71, s71, 0x80000
    buffer_load_dwordx4 v2, s[4:7], s71 offen lds
    s_add_u32 m0, m0, 1024
    s_add_u32 s71, s71, 0x80000
    buffer_load_dwordx4 v3, s[4:7], s71 offen lds
    s_add_u32 s65, s65, 128
    s_sub_u32 s63, 4, s72
    s_cmp_ge_u32 s63, 4
    s_cbranch_scc1 L01X1
    s_buffer_load_dwordx2 s[58:59], s[16:19], s60 offset:60
    s_buffer_load_dwordx2 s[58:59], s[16:19], s60 offset:8252
    s_buffer_load_dwordx2 s[58:59], s[16:19], s60 offset:16444
    s_buffer_load_dwordx2 s[58:59], s[16:19], s60 offset:24636
    s_add_u32 s60, s60, 32768
L01X1:
    s_mov_b32 s68, s69
    s_add_u32 s69, s69, 49152
    s_cmp_eq_u32 s69, 147456
    s_cselect_b32 s69, 0, s69
    s_sub_u32 s72, s72, 1
    s_cmp_lg_u32 s72, 0
    s_waitcnt vmcnt(12)
    s_barrier
    s_cbranch_scc1 L01LOOP
    s_add_u32 s71, s68, s74
    s_add_u32 m0, s71, 0
    s_nop 0
    buffer_load_dwordx4 v4, s[32:35], s67 offen lds
    s_add_u32 m0, m0, 2048
    s_add_u32 s67, s67, s70
    buffer_load_dwordx4 v4, s[32:35], s67 offen lds
    s_add_u32 m0, m0, 2048
    s_add_u32 s67, s67, s70
    buffer_load_dwordx4 v12, s[32:35], s67 offen lds
    s_add_u32 m0, m0, 2048
    s_add_u32 s67, s67, s70
    buffer_load_dwordx4 v12, s[32:35], s67 offen lds
    s_add_u32 m0, m0, 2048
    s_add_u32 s67, s67, s70
    buffer_load_dwordx4 v4, s[32:35], s67 offen lds
    s_add_u32 m0, m0, 2048
    s_add_u32 s67, s67, s70
    buffer_load_dwordx4 v4, s[32:35], s67 offen lds
    s_add_u32 m0, m0, 2048
    s_add_u32 s67, s67, s70
    buffer_load_dwordx4 v12, s[32:35], s67 offen lds
    s_add_u32 m0, m0, 2048
    s_add_u32 s67, s67, s70
    buffer_load_dwordx4 v12, s[32:35], s67 offen lds
    s_add_u32 s67, s67, s70
    s_add_u32 s71, s68, s77
    s_add_u32 m0, s71, 40960
    s_mov_b32 s71, s66
    buffer_load_dwordx4 v2, s[4:7], s71 offen lds
    s_add_u32 m0, m0, 1024
    s_add_u32 s71, s71, 0x80000
    buffer_load_dwordx4 v3, s[4:7], s71 offen lds
    s_add_u32 m0, m0, 1024
    s_add_u32 s71, s71, 0x80000
    buffer_load_dwordx4 v2, s[4:7], s71 offen lds
    s_add_u32 m0, m0, 1024
    s_add_u32 s71, s71, 0x80000
    buffer_load_dwordx4 v3, s[4:7], s71 offen lds
    s_add_u32 s66, s66, 128
    v_mov_b32 v7, 150528
    ds_read_b32 v8, v7
    s_waitcnt vmcnt(12)
    s_barrier
    s_add_u32 s71, s68, s74
    s_add_u32 m0, s71, 16384
    s_nop 0
    buffer_load_dwordx4 v4, s[32:35], s67 offen lds
    s_add_u32 m0, m0, 2048
    s_add_u32 s67, s67, s70
    buffer_load_dwordx4 v4, s[32:35], s67 offen lds
    s_add_u32 m0, m0, 2048
    s_add_u32 s67, s67, s70
    buffer_load_dwordx4 v12, s[32:35], s67 offen lds
    s_add_u32 m0, m0, 2048
    s_add_u32 s67, s67, s70
    buffer_load_dwordx4 v12, s[32:35], s67 offen lds
    s_add_u32 m0, m0, 2048
    s_add_u32 s67, s67, s70
    buffer_load_dwordx4 v4, s[32:35], s67 offen lds
    s_add_u32 m0, m0, 2048
    s_add_u32 s67, s67, s70
    buffer_load_dwordx4 v4, s[32:35], s67 offen lds
    s_add_u32 m0, m0, 2048
    s_add_u32 s67, s67, s70
    buffer_load_dwordx4 v12, s[32:35], s67 offen lds
    s_add_u32 m0, m0, 2048
    s_add_u32 s67, s67, s70
    buffer_load_dwordx4 v12, s[32:35], s67 offen lds
    s_add_u32 s67, s67, s70
    buffer_load_dwordx4 v[16:19], v13, s[20:23], s56 offen offset:0 sc1
    buffer_load_dwordx4 v[20:23], v13, s[20:23], s56 offen offset:2048 sc1
    buffer_load_dwordx4 v[24:27], v13, s[20:23], s57 offen offset:0 sc1
    buffer_load_dwordx4 v[28:31], v13, s[20:23], s57 offen offset:2048 sc1
    buffer_load_dwordx4 v[32:35], v13, s[20:23], s62 offen sc1
    buffer_load_dwordx4 v[52:55], v47, s[20:23], s48 offen sc1
    s_lshl_b32 s73, s64, 14
    s_lshl_b32 s71, s40, 7
    s_add_u32 s73, s73, s71
    s_lshl_b32 m0, s64, 11
    s_add_u32 s71, s73, 8192
    buffer_load_dwordx4 v5, s[16:19], s73 offen lds
    s_add_u32 m0, m0, 1024
    s_add_u32 s73, s73, 32768
    buffer_load_dwordx4 v5, s[16:19], s71 offen lds
    s_add_u32 m0, m0, 3072
    s_add_u32 s71, s73, 8192
    buffer_load_dwordx4 v5, s[16:19], s73 offen lds
    s_add_u32 m0, m0, 1024
    s_add_u32 s73, s73, 32768
    buffer_load_dwordx4 v5, s[16:19], s71 offen lds
    s_add_u32 m0, m0, 3072
    s_waitcnt vmcnt(18)
    s_barrier
    s_add_u32 s71, s73, 8192
    buffer_load_dwordx4 v5, s[16:19], s73 offen lds
    s_add_u32 m0, m0, 1024
    s_add_u32 s73, s73, 32768
    buffer_load_dwordx4 v5, s[16:19], s71 offen lds
    s_add_u32 m0, m0, 3072
    s_add_u32 s71, s73, 8192
    buffer_load_dwordx4 v5, s[16:19], s73 offen lds
    s_add_u32 m0, m0, 1024
    s_add_u32 s73, s73, 32768
    buffer_load_dwordx4 v5, s[16:19], s71 offen lds
    s_add_u32 m0, m0, 3072
    s_add_u32 s71, s73, 8192
    buffer_load_dwordx4 v5, s[16:19], s73 offen lds
    s_add_u32 m0, m0, 1024
    s_add_u32 s73, s73, 32768
    buffer_load_dwordx4 v5, s[16:19], s71 offen lds
    s_add_u32 m0, m0, 3072
    s_add_u32 s71, s73, 8192
    buffer_load_dwordx4 v5, s[16:19], s73 offen lds
    s_add_u32 m0, m0, 1024
    s_add_u32 s73, s73, 32768
    buffer_load_dwordx4 v5, s[16:19], s71 offen lds
    s_add_u32 m0, m0, 3072
    s_add_u32 s71, s73, 8192
    buffer_load_dwordx4 v5, s[16:19], s73 offen lds
    s_add_u32 m0, m0, 1024
    s_add_u32 s73, s73, 32768
    buffer_load_dwordx4 v5, s[16:19], s71 offen lds
    s_add_u32 m0, m0, 3072
    s_add_u32 s71, s73, 8192
    buffer_load_dwordx4 v5, s[16:19], s73 offen lds
    s_add_u32 m0, m0, 1024
    s_add_u32 s73, s73, 32768
    buffer_load_dwordx4 v5, s[16:19], s71 offen lds
    s_add_u32 m0, m0, 3072
    s_waitcnt vmcnt(22)
    s_barrier
    s_waitcnt lgkmcnt(0)
    v_readfirstlane_b32 s44, v8
    s_mov_b32 s75, 200000
    s_waitcnt vmcnt(16)
GCHK:
    v_xor_b32 v36, s44, v17
    v_xor_b32 v37, s44, v19
    v_xor_b32 v38, s44, v21
    v_xor_b32 v39, s44, v23
    v_xor_b32 v40, s44, v25
    v_xor_b32 v41, s44, v27
    v_xor_b32 v42, s44, v29
    v_xor_b32 v43, s44, v31
    v_xor_b32 v44, s44, v35
    v_xor_b32 v51, s44, v55
    v_or_b32 v44, v44, v51
    v_or3_b32 v44, v44, v36, v37
    v_or3_b32 v44, v44, v38, v39
    v_or3_b32 v44, v44, v40, v41
    v_or3_b32 v44, v44, v42, v43
    v_cmp_ne_u32 vcc, 0, v44
    v_add_f32 v36, v16, v20
    v_add_f32 v37, v18, v22
    s_cmp_eq_u64 vcc, 0
    s_cbranch_scc1 GOK
    s_sleep 2
    buffer_load_dwordx4 v[16:19], v13, s[20:23], s56 offen offset:0 sc1
    buffer_load_dwordx4 v[20:23], v13, s[20:23], s56 offen offset:2048 sc1
    buffer_load_dwordx4 v[24:27], v13, s[20:23], s57 offen offset:0 sc1
    buffer_load_dwordx4 v[28:31], v13, s[20:23], s57 offen offset:2048 sc1
    buffer_load_dwordx4 v[32:35], v13, s[20:23], s62 offen sc1
    buffer_load_dwordx4 v[52:55], v47, s[20:23], s48 offen sc1
    s_sub_u32 s75, s75, 1
    s_cmp_lg_u32 s75, 0
    s_waitcnt vmcnt(0)
    s_cbranch_scc1 GCHK
GOK:
    v_add_f32 v38, v24, v28
    v_add_f32 v39, v26, v30
    v_add_f32 v36, v36, v38
    v_add_f32 v37, v37, v39
    ds_write_b64 v45, v[36:37]
    ds_write_b64 v45, v[32:33] offset:1024
    ds_write_b32 v46, v33
    ds_write_b32 v48, v53
    s_waitcnt lgkmcnt(0)
    s_barrier
    s_cmp_eq_u32 s43, 0
    s_cbranch_scc1 L01GLU
    s_add_u32 s71, s73, 8192
    buffer_load_dwordx4 v5, s[16:19], s73 offen lds
    s_add_u32 m0, m0, 1024
    s_add_u32 s73, s73, 32768
    buffer_load_dwordx4 v5, s[16:19], s71 offen lds
    s_add_u32 m0, m0, 3072
    s_waitcnt vmcnt(4)
    s_add_u32 s71, s73, 8192
    buffer_load_dwordx4 v5, s[16:19], s73 offen lds
    s_add_u32 m0, m0, 1024
    s_add_u32 s73, s73, 32768
    buffer_load_dwordx4 v5, s[16:19], s71 offen lds
    s_add_u32 m0, m0, 3072
    s_waitcnt vmcnt(4)
    s_add_u32 s71, s73, 8192
    buffer_load_dwordx4 v5, s[16:19], s73 offen lds
    s_add_u32 m0, m0, 1024
    s_add_u32 s73, s73, 32768
    buffer_load_dwordx4 v5, s[16:19], s71 offen lds
    s_add_u32 m0, m0, 3072
    s_waitcnt vmcnt(4)
    s_add_u32 s71, s73, 8192
    buffer_load_dwordx4 v5, s[16:19], s73 offen lds
    s_add_u32 m0, m0, 1024
    s_add_u32 s73, s73, 32768
    buffer_load_dwordx4 v5, s[16:19], s71 offen lds
    s_add_u32 m0, m0, 3072
    s_waitcnt vmcnt(4)
    s_add_u32 s71, s73, 8192
    buffer_load_dwordx4 v5, s[16:19], s73 offen lds
    s_add_u32 m0, m0, 1024
    s_add_u32 s73, s73, 32768
    buffer_load_dwordx4 v5, s[16:19], s71 offen lds
    s_add_u32 m0, m0, 3072
    s_waitcnt vmcnt(4)
    s_add_u32 s71, s73, 8192
    buffer_load_dwordx4 v5, s[16:19], s73 offen lds
    s_add_u32 m0, m0, 1024
    s_add_u32 s73, s73, 32768
    buffer_load_dwordx4 v5, s[16:19], s71 offen lds
    s_add_u32 m0, m0, 3072
    s_waitcnt vmcnt(4)
    s_add_u32 s71, s73, 8192
    buffer_load_dwordx4 v5, s[16:19], s73 offen lds
    s_add_u32 m0, m0, 1024
    s_add_u32 s73, s73, 32768
    buffer_load_dwordx4 v5, s[16:19], s71 offen lds
    s_add_u32 m0, m0, 3072
    s_waitcnt vmcnt(4)
    s_add_u32 s71, s73, 8192
    buffer_load_dwordx4 v5, s[16:19], s73 offen lds
    s_add_u32 m0, m0, 1024
    s_add_u32 s73, s73, 32768
    buffer_load_dwordx4 v5, s[16:19], s71 offen lds
    s_add_u32 m0, m0, 3072
    s_waitcnt vmcnt(4)
    s_add_u32 s71, s73, 8192
    buffer_load_dwordx4 v5, s[16:19], s73 offen lds
    s_add_u32 m0, m0, 1024
    s_add_u32 s73, s73, 32768
    buffer_load_dwordx4 v5, s[16:19], s71 offen lds
    s_add_u32 m0, m0, 3072
    s_waitcnt vmcnt(4)
    s_add_u32 s71, s73, 8192
    buffer_load_dwordx4 v5, s[16:19], s73 offen lds
    s_add_u32 m0, m0, 1024
    s_add_u32 s73, s73, 32768
    buffer_load_dwordx4 v5, s[16:19], s71 offen lds
    s_add_u32 m0, m0, 3072
    s_waitcnt vmcnt(4)
    s_add_u32 s71, s73, 8192
    buffer_load_dwordx4 v5, s[16:19], s73 offen lds
    s_add_u32 m0, m0, 1024
    s_add_u32 s73, s73, 32768
    buffer_load_dwordx4 v5, s[16:19], s71 offen lds
    s_add_u32 m0, m0, 3072
    s_waitcnt vmcnt(4)
    s_add_u32 s71, s73, 8192
    buffer_load_dwordx4 v5, s[16:19], s73 offen lds
    s_add_u32 m0, m0, 1024
    s_add_u32 s73, s73, 32768
    buffer_load_dwordx4 v5, s[16:19], s71 offen lds
    s_add_u32 m0, m0, 3072
    s_waitcnt vmcnt(4)
    s_add_u32 s71, s73, 8192
    buffer_load_dwordx4 v5, s[16:19], s73 offen lds
    s_add_u32 m0, m0, 1024
    s_add_u32 s73, s73, 32768
    buffer_load_dwordx4 v5, s[16:19], s71 offen lds
    s_add_u32 m0, m0, 3072
    s_waitcnt vmcnt(4)
    s_add_u32 s71, s73, 8192
    buffer_load_dwordx4 v5, s[16:19], s73 offen lds
    s_add_u32 m0, m0, 1024
    s_add_u32 s73, s73, 32768
    buffer_load_dwordx4 v5, s[16:19], s71 offen lds
    s_add_u32 m0, m0, 3072
    s_waitcnt vmcnt(4)
    s_add_u32 s71, s73, 8192
    buffer_load_dwordx4 v5, s[16:19], s73 offen lds
    s_add_u32 m0, m0, 1024
    s_add_u32 s73, s73, 32768
    buffer_load_dwordx4 v5, s[16:19], s71 offen lds
    s_add_u32 m0, m0, 3072
    s_add_u32 s71, s73, 8192
    buffer_load_dwordx4 v5, s[16:19], s73 offen lds
    s_add_u32 m0, m0, 1024
    s_add_u32 s73, s73, 32768
    buffer_load_dwordx4 v5, s[16:19], s71 offen lds
    s_add_u32 m0, m0, 3072
    s_add_u32 s71, s73, 8192
    buffer_load_dwordx4 v5, s[16:19], s73 offen lds
    s_add_u32 m0, m0, 1024
    s_add_u32 s73, s73, 32768
    buffer_load_dwordx4 v5, s[16:19], s71 offen lds
    s_add_u32 m0, m0, 3072
    s_add_u32 s71, s73, 8192
    buffer_load_dwordx4 v5, s[16:19], s73 offen lds
    s_add_u32 m0, m0, 1024
    s_add_u32 s73, s73, 32768
    buffer_load_dwordx4 v5, s[16:19], s71 offen lds
    s_add_u32 m0, m0, 3072
    s_add_u32 s71, s73, 8192
    buffer_load_dwordx4 v5, s[16:19], s73 offen lds
    s_add_u32 m0, m0, 1024
    s_add_u32 s73, s73, 32768
    buffer_load_dwordx4 v5, s[16:19], s71 offen lds
    s_add_u32 m0, m0, 3072
    s_add_u32 s71, s73, 8192
    buffer_load_dwordx4 v5, s[16:19], s73 offen lds
    s_add_u32 m0, m0, 1024
    s_add_u32 s73, s73, 32768
    buffer_load_dwordx4 v5, s[16:19], s71 offen lds
    s_add_u32 m0, m0, 3072
    s_add_u32 s71, s73, 8192
    buffer_load_dwordx4 v5, s[16:19], s73 offen lds
    s_add_u32 m0, m0, 1024
    s_add_u32 s73, s73, 32768
    buffer_load_dwordx4 v5, s[16:19], s71 offen lds
    s_add_u32 m0, m0, 3072
    s_add_u32 s71, s73, 8192
    buffer_load_dwordx4 v5, s[16:19], s73 offen lds
    s_add_u32 m0, m0, 1024
    s_add_u32 s73, s73, 32768
    buffer_load_dwordx4 v5, s[16:19], s71 offen lds
    s_add_u32 m0, m0, 3072
    s_add_u32 s71, s73, 8192
    buffer_load_dwordx4 v5, s[16:19], s73 offen lds
    s_add_u32 m0, m0, 1024
    s_add_u32 s73, s73, 32768
    buffer_load_dwordx4 v5, s[16:19], s71 offen lds
    s_add_u32 m0, m0, 3072
    s_add_u32 s71, s73, 8192
    buffer_load_dwordx4 v5, s[16:19], s73 offen lds
    s_add_u32 m0, m0, 1024
    s_add_u32 s73, s73, 32768
    buffer_load_dwordx4 v5, s[16:19], s71 offen lds
    s_add_u32 m0, m0, 3072
    s_add_u32 s71, s73, 8192
    buffer_load_dwordx4 v5, s[16:19], s73 offen lds
    s_add_u32 m0, m0, 1024
    s_add_u32 s73, s73, 32768
    buffer_load_dwordx4 v5, s[16:19], s71 offen lds
    s_add_u32 m0, m0, 3072
    s_add_u32 s71, s73, 8192
    buffer_load_dwordx4 v5, s[16:19], s73 offen lds
    s_add_u32 m0, m0, 1024
    s_add_u32 s73, s73, 32768
    buffer_load_dwordx4 v5, s[16:19], s71 offen lds
    s_add_u32 m0, m0, 3072
    s_add_u32 s71, s73, 8192
    buffer_load_dwordx4 v5, s[16:19], s73 offen lds
    s_add_u32 m0, m0, 1024
    s_add_u32 s73, s73, 32768
    buffer_load_dwordx4 v5, s[16:19], s71 offen lds
    s_add_u32 m0, m0, 3072
    s_add_u32 s71, s73, 8192
    buffer_load_dwordx4 v5, s[16:19], s73 offen lds
    s_add_u32 m0, m0, 1024
    s_add_u32 s73, s73, 32768
    buffer_load_dwordx4 v5, s[16:19], s71 offen lds
    s_add_u32 m0, m0, 7168
    s_add_u32 s71, s73, 8192
    buffer_load_dwordx4 v5, s[16:19], s73 offen lds
    s_add_u32 m0, m0, 1024
    s_add_u32 s73, s73, 32768
    buffer_load_dwordx4 v5, s[16:19], s71 offen lds
    s_add_u32 m0, m0, 3072
    s_add_u32 s71, s73, 8192
    buffer_load_dwordx4 v5, s[16:19], s73 offen lds
    s_add_u32 m0, m0, 1024
    s_add_u32 s73, s73, 32768
    buffer_load_dwordx4 v5, s[16:19], s71 offen lds
    s_add_u32 m0, m0, 3072
    s_add_u32 s71, s73, 8192
    buffer_load_dwordx4 v5, s[16:19], s73 offen lds
    s_add_u32 m0, m0, 1024
    s_add_u32 s73, s73, 32768
    buffer_load_dwordx4 v5, s[16:19], s71 offen lds
    s_add_u32 s71, s73, 8192
    buffer_load_dwordx4 v[64:67], v5, s[16:19], s73 offen
    s_add_u32 s73, s73, 32768
    buffer_load_dwordx4 v[68:71], v5, s[16:19], s71 offen
    s_add_u32 s71, s73, 8192
    buffer_load_dwordx4 v[72:75], v5, s[16:19], s73 offen
    s_add_u32 s73, s73, 32768
    buffer_load_dwordx4 v[76:79], v5, s[16:19], s71 offen
    s_add_u32 s71, s73, 8192
    buffer_load_dwordx4 v[80:83], v5, s[16:19], s73 offen
    s_add_u32 s73, s73, 32768
    buffer_load_dwordx4 v[84:87], v5, s[16:19], s71 offen
    s_add_u32 s71, s73, 8192
    buffer_load_dwordx4 v[88:91], v5, s[16:19], s73 offen
    s_add_u32 s73, s73, 32768
    buffer_load_dwordx4 v[92:95], v5, s[16:19], s71 offen
    s_add_u32 s71, s73, 8192
    buffer_load_dwordx4 v[96:99], v5, s[16:19], s73 offen
    s_add_u32 s73, s73, 32768
    buffer_load_dwordx4 v[100:103], v5, s[16:19], s71 offen
    s_add_u32 s71, s73, 8192
    buffer_load_dwordx4 v[104:107], v5, s[16:19], s73 offen
    s_add_u32 s73, s73, 32768
    buffer_load_dwordx4 v[108:111], v5, s[16:19], s71 offen
    s_add_u32 s71, s73, 8192
    buffer_load_dwordx4 v[112:115], v5, s[16:19], s73 offen
    s_add_u32 s73, s73, 32768
    buffer_load_dwordx4 v[116:119], v5, s[16:19], s71 offen
    s_add_u32 s71, s73, 8192
    buffer_load_dwordx4 v[120:123], v5, s[16:19], s73 offen
    s_add_u32 s73, s73, 32768
    buffer_load_dwordx4 v[124:127], v5, s[16:19], s71 offen
    v_mov_b32 v7, 150532
    s_mov_b32 s75, 200000
CW2:
    ds_read_b32 v8, v7
    s_waitcnt lgkmcnt(0)
    v_readfirstlane_b32 s76, v8
    s_sub_u32 s75, s75, 1
    s_cmp_eq_u32 s75, 0
    s_cbranch_scc1 CWD2
    s_sleep 1
    s_cmp_lt_u32 s76, 4
    s_cbranch_scc1 CW2
CWD2:
    buffer_load_dword v11, v10, s[20:23], s61 offen sc1
    s_add_u32 s71, s73, 8192
    buffer_load_dwordx4 v[128:131], v5, s[16:19], s73 offen
    s_add_u32 s73, s73, 32768
    buffer_load_dwordx4 v[132:135], v5, s[16:19], s71 offen
    s_add_u32 s71, s73, 8192
    buffer_load_dwordx4 v[136:139], v5, s[16:19], s73 offen
    s_add_u32 s73, s73, 32768
    buffer_load_dwordx4 v[140:143], v5, s[16:19], s71 offen
    s_add_u32 s71, s73, 8192
    buffer_load_dwordx4 v[144:147], v5, s[16:19], s73 offen
    s_add_u32 s73, s73, 32768
    buffer_load_dwordx4 v[148:151], v5, s[16:19], s71 offen
    s_add_u32 s71, s73, 8192
    buffer_load_dwordx4 v[152:155], v5, s[16:19], s73 offen
    s_add_u32 s73, s73, 32768
    buffer_load_dwordx4 v[156:159], v5, s[16:19], s71 offen
    s_add_u32 s71, s73, 8192
    buffer_load_dwordx4 v[160:163], v5, s[16:19], s73 offen
    s_add_u32 s73, s73, 32768
    buffer_load_dwordx4 v[164:167], v5, s[16:19], s71 offen
    s_add_u32 s71, s73, 8192
    buffer_load_dwordx4 v[168:171], v5, s[16:19], s73 offen
    s_add_u32 s73, s73, 32768
    buffer_load_dwordx4 v[172:175], v5, s[16:19], s71 offen
    s_add_u32 s71, s73, 8192
    buffer_load_dwordx4 v[176:179], v5, s[16:19], s73 offen
    s_add_u32 s73, s73, 32768
    buffer_load_dwordx4 v[180:183], v5, s[16:19], s71 offen
    s_add_u32 s71, s73, 8192
    buffer_load_dwordx4 v[184:187], v5, s[16:19], s73 offen
    s_add_u32 s73, s73, 32768
    buffer_load_dwordx4 v[188:191], v5, s[16:19], s71 offen
    s_add_u32 s71, s73, 8192
    buffer_load_dwordx4 v[192:195], v5, s[16:19], s73 offen
    s_add_u32 s73, s73, 32768
    buffer_load_dwordx4 v[196:199], v5, s[16:19], s71 offen
    s_branch L01JOIN
L01GLU:
    s_add_u32 s71, s73, 8192
    buffer_load_dwordx4 v5, s[16:19], s73 offen lds
    s_add_u32 m0, m0, 1024
    s_add_u32 s73, s73, 32768
    buffer_load_dwordx4 v5, s[16:19], s71 offen lds
    s_add_u32 m0, m0, 3072
    s_waitcnt vmcnt(4)
    s_add_u32 s71, s73, 8192
    buffer_load_dwordx4 v5, s[16:19], s73 offen lds
    s_add_u32 m0, m0, 1024
    s_add_u32 s73, s73, 32768
    buffer_load_dwordx4 v5, s[16:19], s71 offen lds
    s_add_u32 m0, m0, 3072
    s_waitcnt vmcnt(4)
    s_add_u32 s71, s73, 8192
    buffer_load_dwordx4 v5, s[16:19], s73 offen lds
    s_add_u32 m0, m0, 1024
    s_add_u32 s73, s73, 32768
    buffer_load_dwordx4 v5, s[16:19], s71 offen lds
    s_add_u32 m0, m0, 3072
    s_waitcnt vmcnt(4)
    s_add_u32 s71, s73, 8192
    buffer_load_dwordx4 v5, s[16:19], s73 offen lds
    s_add_u32 m0, m0, 1024
    s_add_u32 s73, s73, 32768
    buffer_load_dwordx4 v5, s[16:19], s71 offen lds
    s_add_u32 m0, m0, 3072
    s_waitcnt vmcnt(4)
    s_add_u32 s71, s73, 8192
    buffer_load_dwordx4 v5, s[16:19], s73 offen lds
    s_add_u32 m0, m0, 1024
    s_add_u32 s73, s73, 32768
    buffer_load_dwordx4 v5, s[16:19], s71 offen lds
    s_add_u32 m0, m0, 3072
    s_waitcnt vmcnt(4)
    s_add_u32 s71, s73, 8192
    buffer_load_dwordx4 v5, s[16:19], s73 offen lds
    s_add_u32 m0, m0, 1024
    s_add_u32 s73, s73, 32768
    buffer_load_dwordx4 v5, s[16:19], s71 offen lds
    s_add_u32 m0, m0, 3072
    s_waitcnt vmcnt(4)
    s_add_u32 s71, s73, 8192
    buffer_load_dwordx4 v5, s[16:19], s73 offen lds
    s_add_u32 m0, m0, 1024
    s_add_u32 s73, s73, 32768
    buffer_load_dwordx4 v5, s[16:19], s71 offen lds
    s_add_u32 m0, m0, 3072
    s_waitcnt vmcnt(4)
    s_add_u32 s71, s73, 8192
    buffer_load_dwordx4 v5, s[16:19], s73 offen lds
    s_add_u32 m0, m0, 1024
    s_add_u32 s73, s73, 32768
    buffer_load_dwordx4 v5, s[16:19], s71 offen lds
    s_add_u32 m0, m0, 3072
    s_waitcnt vmcnt(4)
    s_add_u32 s71, s73, 8192
    buffer_load_dwordx4 v5, s[16:19], s73 offen lds
    s_add_u32 m0, m0, 1024
    s_add_u32 s73, s73, 32768
    buffer_load_dwordx4 v5, s[16:19], s71 offen lds
    s_add_u32 m0, m0, 3072
    s_waitcnt vmcnt(4)
    s_add_u32 s71, s73, 8192
    buffer_load_dwordx4 v5, s[16:19], s73 offen lds
    s_add_u32 m0, m0, 1024
    s_add_u32 s73, s73, 32768
    buffer_load_dwordx4 v5, s[16:19], s71 offen lds
    s_add_u32 m0, m0, 3072
    s_waitcnt vmcnt(4)
    s_add_u32 s71, s73, 8192
    buffer_load_dwordx4 v5, s[16:19], s73 offen lds
    s_add_u32 m0, m0, 1024
    s_add_u32 s73, s73, 32768
    buffer_load_dwordx4 v5, s[16:19], s71 offen lds
    s_add_u32 m0, m0, 3072
    s_waitcnt vmcnt(4)
    s_add_u32 s71, s73, 8192
    buffer_load_dwordx4 v5, s[16:19], s73 offen lds
    s_add_u32 m0, m0, 1024
    s_add_u32 s73, s73, 32768
    buffer_load_dwordx4 v5, s[16:19], s71 offen lds
    s_add_u32 m0, m0, 3072
    s_waitcnt vmcnt(4)
    s_add_u32 s71, s73, 8192
    buffer_load_dwordx4 v5, s[16:19], s73 offen lds
    s_add_u32 m0, m0, 1024
    s_add_u32 s73, s73, 32768
    buffer_load_dwordx4 v5, s[16:19], s71 offen lds
    s_add_u32 m0, m0, 3072
    s_waitcnt vmcnt(4)
    s_add_u32 s71, s73, 8192
    buffer_load_dwordx4 v5, s[16:19], s73 offen lds
    s_add_u32 m0, m0, 1024
    s_add_u32 s73, s73, 32768
    buffer_load_dwordx4 v5, s[16:19], s71 offen lds
    s_add_u32 m0, m0, 3072
    s_waitcnt vmcnt(4)
    v_mov_b32 v7, 150532
    s_mov_b32 s75, 200000
CW3:
    ds_read_b32 v8, v7
    s_waitcnt lgkmcnt(0)
    v_readfirstlane_b32 s76, v8
    s_sub_u32 s75, s75, 1
    s_cmp_eq_u32 s75, 0
    s_cbranch_scc1 CWD3
    s_sleep 1
    s_cmp_lt_u32 s76, 4
    s_cbranch_scc1 CW3
CWD3:
    s_add_u32 s71, s73, 8192
    buffer_load_dwordx4 v5, s[16:19], s73 offen lds
    s_add_u32 m0, m0, 1024
    s_add_u32 s73, s73, 32768
    buffer_load_dwordx4 v5, s[16:19], s71 offen lds
    s_add_u32 m0, m0, 3072
    s_add_u32 s71, s73, 8192
    buffer_load_dwordx4 v5, s[16:19], s73 offen lds
    s_add_u32 m0, m0, 1024
    s_add_u32 s73, s73, 32768
    buffer_load_dwordx4 v5, s[16:19], s71 offen lds
    s_add_u32 m0, m0, 3072
    s_add_u32 s71, s73, 8192
    buffer_load_dwordx4 v5, s[16:19], s73 offen lds
    s_add_u32 m0, m0, 1024
    s_add_u32 s73, s73, 32768
    buffer_load_dwordx4 v5, s[16:19], s71 offen lds
    s_add_u32 m0, m0, 3072
    s_add_u32 s71, s73, 8192
    buffer_load_dwordx4 v5, s[16:19], s73 offen lds
    s_add_u32 m0, m0, 1024
    s_add_u32 s73, s73, 32768
    buffer_load_dwordx4 v5, s[16:19], s71 offen lds
    s_add_u32 m0, m0, 3072
    s_add_u32 s71, s73, 8192
    buffer_load_dwordx4 v5, s[16:19], s73 offen lds
    s_add_u32 m0, m0, 1024
    s_add_u32 s73, s73, 32768
    buffer_load_dwordx4 v5, s[16:19], s71 offen lds
    s_add_u32 m0, m0, 3072
    s_add_u32 s71, s73, 8192
    buffer_load_dwordx4 v5, s[16:19], s73 offen lds
    s_add_u32 m0, m0, 1024
    s_add_u32 s73, s73, 32768
    buffer_load_dwordx4 v5, s[16:19], s71 offen lds
    s_add_u32 m0, m0, 3072
    s_add_u32 s71, s73, 8192
    buffer_load_dwordx4 v5, s[16:19], s73 offen lds
    s_add_u32 m0, m0, 1024
    s_add_u32 s73, s73, 32768
    buffer_load_dwordx4 v5, s[16:19], s71 offen lds
    s_add_u32 m0, m0, 3072
    s_add_u32 s71, s73, 8192
    buffer_load_dwordx4 v5, s[16:19], s73 offen lds
    s_add_u32 m0, m0, 1024
    s_add_u32 s73, s73, 32768
    buffer_load_dwordx4 v5, s[16:19], s71 offen lds
    s_add_u32 m0, m0, 3072
    s_add_u32 s71, s73, 8192
    buffer_load_dwordx4 v5, s[16:19], s73 offen lds
    s_add_u32 m0, m0, 1024
    s_add_u32 s73, s73, 32768
    buffer_load_dwordx4 v5, s[16:19], s71 offen lds
    s_add_u32 m0, m0, 3072
    s_add_u32 s71, s73, 8192
    buffer_load_dwordx4 v5, s[16:19], s73 offen lds
    s_add_u32 m0, m0, 1024
    s_add_u32 s73, s73, 32768
    buffer_load_dwordx4 v5, s[16:19], s71 offen lds
    s_add_u32 m0, m0, 3072
    s_add_u32 s71, s73, 8192
    buffer_load_dwordx4 v5, s[16:19], s73 offen lds
    s_add_u32 m0, m0, 1024
    s_add_u32 s73, s73, 32768
    buffer_load_dwordx4 v5, s[16:19], s71 offen lds
    s_add_u32 m0, m0, 3072
    s_add_u32 s71, s73, 8192
    buffer_load_dwordx4 v5, s[16:19], s73 offen lds
    s_add_u32 m0, m0, 1024
    s_add_u32 s73, s73, 32768
    buffer_load_dwordx4 v5, s[16:19], s71 offen lds
    s_add_u32 m0, m0, 3072
    s_add_u32 s71, s73, 8192
    buffer_load_dwordx4 v5, s[16:19], s73 offen lds
    s_add_u32 m0, m0, 1024
    s_add_u32 s73, s73, 32768
    buffer_load_dwordx4 v5, s[16:19], s71 offen lds
    s_add_u32 m0, m0, 3072
    s_add_u32 s71, s73, 8192
    buffer_load_dwordx4 v5, s[16:19], s73 offen lds
    s_add_u32 m0, m0, 1024
    s_add_u32 s73, s73, 32768
    buffer_load_dwordx4 v5, s[16:19], s71 offen lds
    s_add_u32 m0, m0, 7168
    s_add_u32 s71, s73, 8192
    buffer_load_dwordx4 v5, s[16:19], s73 offen lds
    s_add_u32 m0, m0, 1024
    s_add_u32 s73, s73, 32768
    buffer_load_dwordx4 v5, s[16:19], s71 offen lds
    s_add_u32 m0, m0, 3072
    s_add_u32 s71, s73, 8192
    buffer_load_dwordx4 v5, s[16:19], s73 offen lds
    s_add_u32 m0, m0, 1024
    s_add_u32 s73, s73, 32768
    buffer_load_dwordx4 v5, s[16:19], s71 offen lds
    s_add_u32 m0, m0, 3072
    s_add_u32 s71, s73, 8192
    buffer_load_dwordx4 v5, s[16:19], s73 offen lds
    s_add_u32 m0, m0, 1024
    s_add_u32 s73, s73, 32768
    buffer_load_dwordx4 v5, s[16:19], s71 offen lds
    s_add_u32 s71, s73, 8192
    buffer_load_dwordx4 v[64:67], v5, s[16:19], s73 offen
    s_add_u32 s73, s73, 32768
    buffer_load_dwordx4 v[68:71], v5, s[16:19], s71 offen
    s_add_u32 s71, s73, 8192
    buffer_load_dwordx4 v[72:75], v5, s[16:19], s73 offen
    s_add_u32 s73, s73, 32768
    buffer_load_dwordx4 v[76:79], v5, s[16:19], s71 offen
    s_add_u32 s71, s73, 8192
    buffer_load_dwordx4 v[80:83], v5, s[16:19], s73 offen
    s_add_u32 s73, s73, 32768
    buffer_load_dwordx4 v[84:87], v5, s[16:19], s71 offen
    s_add_u32 s71, s73, 8192
    buffer_load_dwordx4 v[88:91], v5, s[16:19], s73 offen
    s_add_u32 s73, s73, 32768
    buffer_load_dwordx4 v[92:95], v5, s[16:19], s71 offen
    s_add_u32 s71, s73, 8192
    buffer_load_dwordx4 v[96:99], v5, s[16:19], s73 offen
    s_add_u32 s73, s73, 32768
    buffer_load_dwordx4 v[100:103], v5, s[16:19], s71 offen
    s_add_u32 s71, s73, 8192
    buffer_load_dwordx4 v[104:107], v5, s[16:19], s73 offen
    s_add_u32 s73, s73, 32768
    buffer_load_dwordx4 v[108:111], v5, s[16:19], s71 offen
    s_add_u32 s71, s73, 8192
    buffer_load_dwordx4 v[112:115], v5, s[16:19], s73 offen
    s_add_u32 s73, s73, 32768
    buffer_load_dwordx4 v[116:119], v5, s[16:19], s71 offen
    s_add_u32 s71, s73, 8192
    buffer_load_dwordx4 v[120:123], v5, s[16:19], s73 offen
    s_add_u32 s73, s73, 32768
    buffer_load_dwordx4 v[124:127], v5, s[16:19], s71 offen
    buffer_load_dword v11, v10, s[20:23], s61 offen sc1
    s_add_u32 s71, s73, 8192
    buffer_load_dwordx4 v[128:131], v5, s[16:19], s73 offen
    s_add_u32 s73, s73, 32768
    buffer_load_dwordx4 v[132:135], v5, s[16:19], s71 offen
    s_add_u32 s71, s73, 8192
    buffer_load_dwordx4 v[136:139], v5, s[16:19], s73 offen
    s_add_u32 s73, s73, 32768
    buffer_load_dwordx4 v[140:143], v5, s[16:19], s71 offen
    s_add_u32 s71, s73, 8192
    buffer_load_dwordx4 v[144:147], v5, s[16:19], s73 offen
    s_add_u32 s73, s73, 32768
    buffer_load_dwordx4 v[148:151], v5, s[16:19], s71 offen
    s_add_u32 s71, s73, 8192
    buffer_load_dwordx4 v[152:155], v5, s[16:19], s73 offen
    s_add_u32 s73, s73, 32768
    buffer_load_dwordx4 v[156:159], v5, s[16:19], s71 offen
    s_add_u32 s71, s73, 8192
    buffer_load_dwordx4 v[160:163], v5, s[16:19], s73 offen
    s_add_u32 s73, s73, 32768
    buffer_load_dwordx4 v[164:167], v5, s[16:19], s71 offen
    s_add_u32 s71, s73, 8192
    buffer_load_dwordx4 v[168:171], v5, s[16:19], s73 offen
    s_add_u32 s73, s73, 32768
    buffer_load_dwordx4 v[172:175], v5, s[16:19], s71 offen
    s_add_u32 s71, s73, 8192
    buffer_load_dwordx4 v[176:179], v5, s[16:19], s73 offen
    s_add_u32 s73, s73, 32768
    buffer_load_dwordx4 v[180:183], v5, s[16:19], s71 offen
    s_add_u32 s71, s73, 8192
    buffer_load_dwordx4 v[184:187], v5, s[16:19], s73 offen
    s_add_u32 s73, s73, 32768
    buffer_load_dwordx4 v[188:191], v5, s[16:19], s71 offen
    s_add_u32 s71, s73, 8192
    buffer_load_dwordx4 v[192:195], v5, s[16:19], s73 offen
    s_add_u32 s73, s73, 32768
    buffer_load_dwordx4 v[196:199], v5, s[16:19], s71 offen
L01JOIN:
    v_and_b32 v6, 3, v0
    v_bfe_u32 v7, v0, 3, 2
    v_lshl_add_u32 v6, v7, 2, v6
    v_bfe_u32 v7, v0, 2, 1
    v_lshl_add_u32 v6, v7, 4, v6
    v_and_b32 v7, 32, v0
    s_lshl_b32 s66, s40, 6
    v_add3_u32 v6, v6, v7, s66
    v_sub_u32 v7, 512, v6
    v_and_b32 v7, 255, v7
    s_sub_u32 s67, 32, s39
    s_and_b32 s67, s67, 31
    s_cmp_ge_u32 s40, 4
    s_cselect_b64 s[68:69], -1, 0
    s_cselect_b32 s67, s67, s39
    v_cmp_eq_u32 vcc, 0, v6
    v_cndmask_b32 v7, v6, v7, s[68:69]
    v_lshlrev_b32 v9, 4, v7
    v_mov_b32 v7, 0x40000000
    s_lshl_b32 s67, s67, 16
    v_cndmask_b32 v9, v9, v7, vcc
    s_lshl_b32 s66, s64, 15
    s_add_u32 s67, s67, s66
    s_add_u32 s67, s67, 8388608
    s_lshl_b32 s66, s64, 13
    s_add_u32 m0, s66, 98304
    v_bfe_u32 v12, v0, 1, 4
    v_lshlrev_b32 v12, 4, v12
    v_and_b32 v13, 1, v0
    v_add3_u32 v12, v12, v13, 14
    v_lshlrev_b32 v12, 7, v12
    s_mov_b32 s70, 10813440
    s_lshl_b32 s66, s64, 11
    v_lshl_add_u32 v6, v0, 4, s66
    s_cmp_eq_u32 s64, 1
    s_cselect_b32 s70, s70, 0x40000000
    s_cbranch_scc1 L1NOPOLL
    s_mov_b32 s75, 200000
    s_waitcnt vmcnt(18)
POLL4:
    v_cmp_ne_u32 vcc, s44, v11
    s_nop 1
    s_cmp_eq_u64 vcc, 0
    s_cbranch_scc1 POLLD4
    s_sleep 6
    buffer_load_dword v11, v10, s[20:23], s61 offen sc1
    s_sub_u32 s75, s75, 1
    s_cmp_lg_u32 s75, 0
    s_waitcnt vmcnt(0)
    s_cbranch_scc1 POLL4
POLLD4:
L1NOPOLL:
    s_waitcnt vmcnt(18)
    s_barrier
    s_waitcnt vmcnt(0)
    s_barrier
    buffer_load_dword v11, v12, s[20:23], s70 offen sc1
    ds_write_b128 v6, v[64:67] offset:0
    ds_write_b128 v6, v[68:71] offset:1024
    ds_write_b128 v6, v[72:75] offset:4096
    ds_write_b128 v6, v[76:79] offset:5120
    ds_write_b128 v6, v[80:83] offset:8192
    ds_write_b128 v6, v[84:87] offset:9216
    ds_write_b128 v6, v[88:91] offset:12288
    ds_write_b128 v6, v[92:95] offset:13312
    ds_write_b128 v6, v[96:99] offset:16384
    ds_write_b128 v6, v[100:103] offset:17408
    ds_write_b128 v6, v[104:107] offset:20480
    ds_write_b128 v6, v[108:111] offset:21504
    ds_write_b128 v6, v[112:115] offset:24576
    ds_write_b128 v6, v[116:119] offset:25600
    ds_write_b128 v6, v[120:123] offset:28672
    ds_write_b128 v6, v[124:127] offset:29696
    ds_write_b128 v6, v[128:131] offset:32768
    ds_write_b128 v6, v[132:135] offset:33792
    ds_write_b128 v6, v[136:139] offset:36864
    ds_write_b128 v6, v[140:143] offset:37888
    ds_write_b128 v6, v[144:147] offset:40960
    ds_write_b128 v6, v[148:151] offset:41984
    ds_write_b128 v6, v[152:155] offset:45056
    ds_write_b128 v6, v[156:159] offset:46080
    ds_write_b128 v6, v[160:163] offset:49152
    ds_write_b128 v6, v[164:167] offset:50176
    ds_write_b128 v6, v[168:171] offset:53248
    ds_write_b128 v6, v[172:175] offset:54272
    ds_write_b128 v6, v[176:179] offset:57344
    ds_write_b128 v6, v[180:183] offset:58368
    ds_write_b128 v6, v[184:187] offset:61440
    ds_write_b128 v6, v[188:191] offset:62464
    v_add_u32 v6, 0x10000, v6
    ds_write_b128 v6, v[192:195] offset:0
    ds_write_b128 v6, v[196:199] offset:1024
    s_waitcnt lgkmcnt(0)
    s_barrier
    s_cmp_eq_u32 s64, 0
    s_cbranch_scc1 L0NOPOLL
    s_mov_b32 s75, 200000
    s_waitcnt vmcnt(0)
POLL5:
    v_cmp_ne_u32 vcc, s44, v11
    s_nop 1
    s_cmp_eq_u64 vcc, 0
    s_cbranch_scc1 POLLD5
    s_sleep 6
    buffer_load_dword v11, v12, s[20:23], s70 offen sc1
    s_sub_u32 s75, s75, 1
    s_cmp_lg_u32 s75, 0
    s_waitcnt vmcnt(0)
    s_cbranch_scc1 POLL5
POLLD5:
L0NOPOLL:
    s_barrier
    buffer_load_dwordx4 v9, s[20:23], s67 offen sc1 lds
    s_add_u32 m0, m0, 1024
    s_add_u32 s67, s67, 4096
    buffer_load_dwordx4 v9, s[20:23], s67 offen sc1 lds
    s_add_u32 m0, m0, 1024
    s_add_u32 s67, s67, 4096
    buffer_load_dwordx4 v9, s[20:23], s67 offen sc1 lds
    s_add_u32 m0, m0, 1024
    s_add_u32 s67, s67, 4096
    buffer_load_dwordx4 v9, s[20:23], s67 offen sc1 lds
    s_add_u32 m0, m0, 1024
    s_add_u32 s67, s67, 4096
    buffer_load_dwordx4 v9, s[20:23], s67 offen sc1 lds
    s_add_u32 m0, m0, 1024
    s_add_u32 s67, s67, 4096
    buffer_load_dwordx4 v9, s[20:23], s67 offen sc1 lds
    s_add_u32 m0, m0, 1024
    s_add_u32 s67, s67, 4096
    buffer_load_dwordx4 v9, s[20:23], s67 offen sc1 lds
    s_add_u32 m0, m0, 1024
    s_add_u32 s67, s67, 4096
    buffer_load_dwordx4 v9, s[20:23], s67 offen sc1 lds
    s_add_u32 m0, m0, 1024
    s_add_u32 s67, s67, 4096
    s_waitcnt vmcnt(0)
    s_barrier
    s_endpgm
CWAVE:
    s_setprio 2
    s_and_b32 s64, s2, 1
    s_lshl_b32 s64, s64, 3
    s_and_b32 s65, s45, 7
    s_add_u32 s37, s64, s65
    s_bfe_u32 s64, s2, 0x20001
    s_lshr_b32 s67, s45, 3
    s_mul_i32 s65, s64, 3
    s_add_u32 s65, s65, s67
    s_add_u32 s66, s64, 14
    s_cmp_eq_u32 s67, 3
    s_cselect_b32 s65, s66, s65
    s_lshl_b32 s66, s64, 2
    s_add_u32 s66, s66, s67
    s_sub_u32 s66, s66, 2
    s_cmp_lt_u32 s64, 2
    s_cselect_b32 s38, s65, s66
    s_lshl_b32 s42, s38, 8
    s_sub_u32 s64, s42, 3584
    s_movk_i32 s41, 3584
    s_cmp_ge_u32 s38, 14
    s_cselect_b32 s43, 1, 0
    s_cselect_b32 s41, 1024, s41
    s_cselect_b32 s42, s64, s42
    s_lshl_b32 s34, s41, 9
    s_mov_b32 s35, 0x20000
    s_mov_b32 s6, 0x200000
    s_mov_b32 s7, 0x20000
    v_mov_b32 v117, v0
    v_mov_b32 v8, 0
    v_mov_b32 v9, 0
    v_mov_b32 v10, 0
    v_mov_b32 v11, 0
    v_and_b32 v2, 31, v0
    v_lshrrev_b32 v3, 5, v0
    v_mfma_f32_32x32x16_bf16 v[128:143], v[8:11], v[8:11], 0
    v_mfma_f32_32x32x16_bf16 v[144:159], v[8:11], v[8:11], 0
    v_mfma_f32_32x32x16_bf16 v[160:175], v[8:11], v[8:11], 0
    v_mfma_f32_32x32x16_bf16 v[176:191], v[8:11], v[8:11], 0
    v_mfma_f32_32x32x16_bf16 v[192:207], v[8:11], v[8:11], 0
    v_mfma_f32_32x32x16_bf16 v[208:223], v[8:11], v[8:11], 0
    v_mfma_f32_32x32x16_bf16 v[224:239], v[8:11], v[8:11], 0
    v_mfma_f32_32x32x16_bf16 v[240:255], v[8:11], v[8:11], 0
    s_waitcnt lgkmcnt(0)
    s_mov_b64 s[16:17], s[56:57]
    s_mov_b32 s18, 1835008
    s_mov_b32 s19, 0x20000
    s_mov_b64 s[20:21], s[62:63]
    s_mov_b32 s22, 11534336
    s_mov_b32 s23, 0x20000
    s_mov_b64 s[24:25], s[58:59]
    s_mov_b32 s26, 0x200000
    s_mov_b32 s27, 0x20000
    s_mov_b64 s[28:29], s[60:61]
    s_mov_b32 s30, 256
    s_mov_b32 s31, 0x20000
    s_and_b32 s73, s36, 1
    s_lshr_b32 s74, s36, 1
    s_lshl_b32 s64, s37, 4
    s_add_u32 s64, s64, s38
    s_lshl_b32 s64, s64, 7
    s_add_u32 s61, s64, 10813440
    s_mov_b32 s46, s2
    s_bfe_u32 s47, s46, 0x20001
    s_lshl_b32 s47, s47, 3
    s_and_b32 s39, s45, 7
    s_add_u32 s39, s39, s47
    s_and_b32 s46, s46, 1
    s_lshl_b32 s46, s46, 2
    s_lshr_b32 s40, s45, 3
    s_add_u32 s40, s40, s46
    s_lshl_b32 s46, s73, 5
    s_add_u32 s46, s46, s39
    s_lshl_b32 s56, s46, 10
    s_lshl_b32 s46, s40, 7
    s_add_u32 s56, s56, s46
    s_lshl_b32 s46, s74, 6
    s_add_u32 s56, s56, s46
    s_cmp_eq_u32 s39, 0
    s_cselect_b32 s63, 64, 63
    s_mul_i32 s57, s39, 229376
    s_mov_b32 s60, s47
    s_lshl_b32 s46, s73, 1
    s_add_u32 s46, s46, s74
    s_mul_i32 s46, s46, 57344
    s_add_u32 s57, s57, s46
    s_cmp_eq_u32 s43, 1
    s_cbranch_scc1 CDFT
    s_lshl_b32 s64, s38, 2
    s_add_u32 s64, s64, s36
    s_lshr_b32 s65, s64, 3
    s_mul_i32 s65, s65, 8192
    s_and_b32 s64, s64, 7
    s_lshl_b32 s64, s64, 10
    s_add_u32 s64, s64, s65
    s_lshl_b32 s65, s37, 1
    s_mul_i32 s62, s65, 229376
    s_mov_b32 s58, s47
    s_add_u32 s62, s62, s64
    v_and_b32 v2, 15, v0
    v_lshrrev_b32 v3, 4, v0
    v_lshrrev_b32 v4, 1, v2
    v_xor_b32 v4, v4, v3
    v_lshlrev_b32 v5, 7, v2
    v_lshl_add_u32 v112, v4, 4, v5
    v_add_u32 v112, 81920, v112
    v_xor_b32 v113, 64, v112
    v_bfe_u32 v4, v0, 2, 2
    v_lshlrev_b32 v5, 12, v3
    v_lshl_add_u32 v5, v4, 8, v5
    v_xor_b32 v4, s36, v4
    v_lshl_add_u32 v5, v4, 6, v5
    v_and_b32 v4, 1, v3
    v_lshl_add_u32 v5, v4, 5, v5
    v_and_b32 v4, 3, v0
    v_lshl_add_u32 v5, v4, 3, v5
    v_add_u32 v114, 49152, v5
    v_xor_b32 v115, 32, v114
    s_lshl_b32 s64, s36, 7
    s_add_u32 s64, s64, 147456
    v_lshl_add_u32 v119, v3, 4, s64
    v_lshlrev_b32 v120, 3, v2
    v_add_u32 v120, 148480, v120
    v_mov_b32 v116, 150528
    s_branch CGLU
L2REST:
    s_mov_b64 s[16:17], s[56:57]
    s_mov_b32 s18, 1835008
    s_mov_b32 s19, 0x20000
    s_mov_b64 s[20:21], s[62:63]
    s_mov_b32 s22, 11534336
    s_mov_b32 s23, 0x20000
    s_mov_b64 s[24:25], s[58:59]
    s_mov_b32 s26, 0x200000
    s_mov_b32 s27, 0x20000
    s_mov_b64 s[28:29], s[60:61]
    s_mov_b32 s30, 256
    s_mov_b32 s31, 0x20000
    v_mov_b32 v9, 0xffff0000
    s_barrier
    s_barrier
    buffer_load_dwordx4 v[48:51], v8, s[32:35], s69 offen
    s_add_u32 s69, s69, s70
    buffer_load_dwordx4 v[52:55], v8, s[32:35], s69 offen
    s_add_u32 s69, s69, s72
    buffer_load_dwordx4 v[56:59], v8, s[32:35], s69 offen
    s_add_u32 s69, s69, s70
    buffer_load_dwordx4 v[60:63], v8, s[32:35], s69 offen
    s_add_u32 s69, s69, s72
    s_barrier
    s_waitcnt vmcnt(5)
    v_lshlrev_b32 v16, 16, v32
    v_and_b32 v17, v9, v32
    v_lshlrev_b32 v18, 16, v33
    v_and_b32 v19, v9, v33
    v_lshlrev_b32 v20, 16, v34
    v_and_b32 v21, v9, v34
    v_lshlrev_b32 v22, 16, v35
    v_and_b32 v23, v9, v35
    v_lshlrev_b32 v10, 16, v36
    v_and_b32 v11, v9, v36
    v_add_f32 v16, v16, v10
    v_add_f32 v17, v17, v11
    v_lshlrev_b32 v10, 16, v37
    v_and_b32 v11, v9, v37
    v_add_f32 v18, v18, v10
    v_add_f32 v19, v19, v11
    v_lshlrev_b32 v10, 16, v38
    v_and_b32 v11, v9, v38
    v_add_f32 v20, v20, v10
    v_add_f32 v21, v21, v11
    v_lshlrev_b32 v10, 16, v39
    v_and_b32 v11, v9, v39
    v_add_f32 v22, v22, v10
    v_add_f32 v23, v23, v11
    v_lshlrev_b32 v10, 16, v40
    v_and_b32 v11, v9, v40
    v_add_f32 v16, v16, v10
    v_add_f32 v17, v17, v11
    v_lshlrev_b32 v10, 16, v41
    v_and_b32 v11, v9, v41
    v_add_f32 v18, v18, v10
    v_add_f32 v19, v19, v11
    v_lshlrev_b32 v10, 16, v42
    v_and_b32 v11, v9, v42
    v_add_f32 v20, v20, v10
    v_add_f32 v21, v21, v11
    v_lshlrev_b32 v10, 16, v43
    v_and_b32 v11, v9, v43
    v_add_f32 v22, v22, v10
    v_add_f32 v23, v23, v11
    s_barrier
    s_waitcnt vmcnt(2)
    v_lshlrev_b32 v10, 16, v44
    v_and_b32 v11, v9, v44
    v_add_f32 v16, v16, v10
    v_add_f32 v17, v17, v11
    v_lshlrev_b32 v10, 16, v45
    v_and_b32 v11, v9, v45
    v_add_f32 v18, v18, v10
    v_add_f32 v19, v19, v11
    v_lshlrev_b32 v10, 16, v46
    v_and_b32 v11, v9, v46
    v_add_f32 v20, v20, v10
    v_add_f32 v21, v21, v11
    v_lshlrev_b32 v10, 16, v47
    v_and_b32 v11, v9, v47
    v_add_f32 v22, v22, v10
    v_add_f32 v23, v23, v11
    v_lshlrev_b32 v10, 16, v48
    v_and_b32 v11, v9, v48
    v_add_f32 v16, v16, v10
    v_add_f32 v17, v17, v11
    v_lshlrev_b32 v10, 16, v49
    v_and_b32 v11, v9, v49
    v_add_f32 v18, v18, v10
    v_add_f32 v19, v19, v11
    v_lshlrev_b32 v10, 16, v50
    v_and_b32 v11, v9, v50
    v_add_f32 v20, v20, v10
    v_add_f32 v21, v21, v11
    v_lshlrev_b32 v10, 16, v51
    v_and_b32 v11, v9, v51
    v_add_f32 v22, v22, v10
    v_add_f32 v23, v23, v11
    v_lshlrev_b32 v10, 16, v52
    v_and_b32 v11, v9, v52
    v_add_f32 v16, v16, v10
    v_add_f32 v17, v17, v11
    v_lshlrev_b32 v10, 16, v53
    v_and_b32 v11, v9, v53
    v_add_f32 v18, v18, v10
    v_add_f32 v19, v19, v11
    v_lshlrev_b32 v10, 16, v54
    v_and_b32 v11, v9, v54
    v_add_f32 v20, v20, v10
    v_add_f32 v21, v21, v11
    v_lshlrev_b32 v10, 16, v55
    v_and_b32 v11, v9, v55
    v_add_f32 v22, v22, v10
    v_add_f32 v23, v23, v11
    s_barrier
    buffer_load_dwordx4 v[64:67], v8, s[32:35], s69 offen
    s_add_u32 s69, s69, s70
    buffer_load_dwordx4 v[68:71], v8, s[32:35], s69 offen
    s_add_u32 s69, s69, s72
    buffer_load_dwordx4 v[72:75], v8, s[32:35], s69 offen
    s_add_u32 s69, s69, s70
    buffer_load_dwordx4 v[76:79], v8, s[32:35], s69 offen
    s_add_u32 s69, s69, s72
    buffer_load_dwordx4 v[80:83], v8, s[32:35], s69 offen
    s_add_u32 s69, s69, s70
    buffer_load_dwordx4 v[84:87], v8, s[32:35], s69 offen
    s_add_u32 s69, s69, s72
    buffer_load_dwordx4 v[88:91], v8, s[32:35], s69 offen
    s_add_u32 s69, s69, s70
    buffer_load_dwordx4 v[92:95], v8, s[32:35], s69 offen
    s_add_u32 s69, s69, s72
    s_waitcnt vmcnt(7)
    v_lshlrev_b32 v10, 16, v56
    v_and_b32 v11, v9, v56
    v_add_f32 v16, v16, v10
    v_add_f32 v17, v17, v11
    v_lshlrev_b32 v10, 16, v57
    v_and_b32 v11, v9, v57
    v_add_f32 v18, v18, v10
    v_add_f32 v19, v19, v11
    v_lshlrev_b32 v10, 16, v58
    v_and_b32 v11, v9, v58
    v_add_f32 v20, v20, v10
    v_add_f32 v21, v21, v11
    v_lshlrev_b32 v10, 16, v59
    v_and_b32 v11, v9, v59
    v_add_f32 v22, v22, v10
    v_add_f32 v23, v23, v11
    v_lshlrev_b32 v10, 16, v60
    v_and_b32 v11, v9, v60
    v_add_f32 v16, v16, v10
    v_add_f32 v17, v17, v11
    v_lshlrev_b32 v10, 16, v61
    v_and_b32 v11, v9, v61
    v_add_f32 v18, v18, v10
    v_add_f32 v19, v19, v11
    v_lshlrev_b32 v10, 16, v62
    v_and_b32 v11, v9, v62
    v_add_f32 v20, v20, v10
    v_add_f32 v21, v21, v11
    v_lshlrev_b32 v10, 16, v63
    v_and_b32 v11, v9, v63
    v_add_f32 v22, v22, v10
    v_add_f32 v23, v23, v11
    v_lshlrev_b32 v10, 16, v64
    v_and_b32 v11, v9, v64
    v_add_f32 v16, v16, v10
    v_add_f32 v17, v17, v11
    v_lshlrev_b32 v10, 16, v65
    v_and_b32 v11, v9, v65
    v_add_f32 v18, v18, v10
    v_add_f32 v19, v19, v11
    v_lshlrev_b32 v10, 16, v66
    v_and_b32 v11, v9, v66
    v_add_f32 v20, v20, v10
    v_add_f32 v21, v21, v11
    v_lshlrev_b32 v10, 16, v67
    v_and_b32 v11, v9, v67
    v_add_f32 v22, v22, v10
    v_add_f32 v23, v23, v11
    s_barrier
    s_waitcnt vmcnt(4)
    v_lshlrev_b32 v10, 16, v68
    v_and_b32 v11, v9, v68
    v_add_f32 v16, v16, v10
    v_add_f32 v17, v17, v11
    v_lshlrev_b32 v10, 16, v69
    v_and_b32 v11, v9, v69
    v_add_f32 v18, v18, v10
    v_add_f32 v19, v19, v11
    v_lshlrev_b32 v10, 16, v70
    v_and_b32 v11, v9, v70
    v_add_f32 v20, v20, v10
    v_add_f32 v21, v21, v11
    v_lshlrev_b32 v10, 16, v71
    v_and_b32 v11, v9, v71
    v_add_f32 v22, v22, v10
    v_add_f32 v23, v23, v11
    v_lshlrev_b32 v10, 16, v72
    v_and_b32 v11, v9, v72
    v_add_f32 v16, v16, v10
    v_add_f32 v17, v17, v11
    v_lshlrev_b32 v10, 16, v73
    v_and_b32 v11, v9, v73
    v_add_f32 v18, v18, v10
    v_add_f32 v19, v19, v11
    v_lshlrev_b32 v10, 16, v74
    v_and_b32 v11, v9, v74
    v_add_f32 v20, v20, v10
    v_add_f32 v21, v21, v11
    v_lshlrev_b32 v10, 16, v75
    v_and_b32 v11, v9, v75
    v_add_f32 v22, v22, v10
    v_add_f32 v23, v23, v11
    v_lshlrev_b32 v10, 16, v76
    v_and_b32 v11, v9, v76
    v_add_f32 v16, v16, v10
    v_add_f32 v17, v17, v11
    v_lshlrev_b32 v10, 16, v77
    v_and_b32 v11, v9, v77
    v_add_f32 v18, v18, v10
    v_add_f32 v19, v19, v11
    v_lshlrev_b32 v10, 16, v78
    v_and_b32 v11, v9, v78
    v_add_f32 v20, v20, v10
    v_add_f32 v21, v21, v11
    v_lshlrev_b32 v10, 16, v79
    v_and_b32 v11, v9, v79
    v_add_f32 v22, v22, v10
    v_add_f32 v23, v23, v11
    s_barrier
    s_waitcnt vmcnt(1)
    v_lshlrev_b32 v10, 16, v80
    v_and_b32 v11, v9, v80
    v_add_f32 v16, v16, v10
    v_add_f32 v17, v17, v11
    v_lshlrev_b32 v10, 16, v81
    v_and_b32 v11, v9, v81
    v_add_f32 v18, v18, v10
    v_add_f32 v19, v19, v11
    v_lshlrev_b32 v10, 16, v82
    v_and_b32 v11, v9, v82
    v_add_f32 v20, v20, v10
    v_add_f32 v21, v21, v11
    v_lshlrev_b32 v10, 16, v83
    v_and_b32 v11, v9, v83
    v_add_f32 v22, v22, v10
    v_add_f32 v23, v23, v11
    v_lshlrev_b32 v10, 16, v84
    v_and_b32 v11, v9, v84
    v_add_f32 v16, v16, v10
    v_add_f32 v17, v17, v11
    v_lshlrev_b32 v10, 16, v85
    v_and_b32 v11, v9, v85
    v_add_f32 v18, v18, v10
    v_add_f32 v19, v19, v11
    v_lshlrev_b32 v10, 16, v86
    v_and_b32 v11, v9, v86
    v_add_f32 v20, v20, v10
    v_add_f32 v21, v21, v11
    v_lshlrev_b32 v10, 16, v87
    v_and_b32 v11, v9, v87
    v_add_f32 v22, v22, v10
    v_add_f32 v23, v23, v11
    v_lshlrev_b32 v10, 16, v88
    v_and_b32 v11, v9, v88
    v_add_f32 v16, v16, v10
    v_add_f32 v17, v17, v11
    v_lshlrev_b32 v10, 16, v89
    v_and_b32 v11, v9, v89
    v_add_f32 v18, v18, v10
    v_add_f32 v19, v19, v11
    v_lshlrev_b32 v10, 16, v90
    v_and_b32 v11, v9, v90
    v_add_f32 v20, v20, v10
    v_add_f32 v21, v21, v11
    v_lshlrev_b32 v10, 16, v91
    v_and_b32 v11, v9, v91
    v_add_f32 v22, v22, v10
    v_add_f32 v23, v23, v11
    s_barrier
    s_waitcnt vmcnt(0)
    v_lshlrev_b32 v10, 16, v92
    v_and_b32 v11, v9, v92
    v_add_f32 v16, v16, v10
    v_add_f32 v17, v17, v11
    v_lshlrev_b32 v10, 16, v93
    v_and_b32 v11, v9, v93
    v_add_f32 v18, v18, v10
    v_add_f32 v19, v19, v11
    v_lshlrev_b32 v10, 16, v94
    v_and_b32 v11, v9, v94
    v_add_f32 v20, v20, v10
    v_add_f32 v21, v21, v11
    v_lshlrev_b32 v10, 16, v95
    v_and_b32 v11, v9, v95
    v_add_f32 v22, v22, v10
    v_add_f32 v23, v23, v11
    s_barrier
    v_mov_b32 v12, 150528
    ds_read_b32 v25, v12
    v_permlane32_swap_b32 v16, v20
    v_permlane32_swap_b32 v17, v21
    v_permlane32_swap_b32 v18, v22
    v_permlane32_swap_b32 v19, v23
    s_nop 1
    v_add_f32 v16, v16, v20
    v_add_f32 v17, v17, v21
    v_add_f32 v18, v18, v22
    v_add_f32 v19, v19, v23
    s_nop 1
    v_permlane16_swap_b32 v16, v18
    v_permlane16_swap_b32 v17, v19
    s_nop 1
    v_add_f32 v16, v16, v18
    v_add_f32 v17, v17, v19
    v_and_b32 v10, 7, v0
    v_lshlrev_b32 v10, 3, v10
    v_add_f32_dpp v24, v16, v16 row_ror:8 row_mask:0xf bank_mask:0x3
    s_nop 1
    v_add_f32_dpp v24, v17, v17 row_ror:8 row_mask:0xf bank_mask:0xc
    v_bfe_u32 v11, v0, 5, 1
    v_lshl_add_u32 v10, v11, 2, v10
    v_bfe_u32 v11, v0, 4, 1
    v_lshl_add_u32 v10, v11, 1, v10
    v_bfe_u32 v11, v0, 3, 1
    v_add_u32 v10, v11, v10
    v_lshlrev_b32 v10, 3, v10
    s_lshl_b32 s64, s38, 13
    s_add_u32 s64, s64, 10551296
    s_lshl_b32 s65, s37, 9
    s_add_u32 s65, s64, s65
    s_waitcnt lgkmcnt(0)
    buffer_store_dwordx2 v[24:25], v10, s[20:23], s65 offen sc1
    v_readfirstlane_b32 s44, v25
    s_mov_b32 s46, s2
    s_lshr_b32 s60, s45, 2
    s_lshl_b32 s60, s60, 10
    s_and_b32 s63, s45, 3
    s_lshl_b32 s63, s63, 7
    s_add_u32 s60, s60, s63
    s_and_b32 s63, s46, 1
    s_lshl_b32 s63, s63, 9
    s_add_u32 s60, s60, s63
    s_bfe_u32 s63, s2, 0x20001
    s_mul_i32 s62, s63, 458752
    s_add_u32 s60, s60, 0
    s_add_u32 s62, s62, s60
    s_barrier
    s_barrier
    s_cmp_ge_u32 s60, s62
    s_cselect_b32 s63, 458752, 0
    s_cselect_b32 s62, -1, s62
    s_add_u32 s60, s60, s63
    s_buffer_load_dwordx2 s[58:59], s[16:19], s60 offset:60
    s_buffer_load_dwordx2 s[58:59], s[16:19], s60 offset:8252
    s_buffer_load_dwordx2 s[58:59], s[16:19], s60 offset:16444
    s_buffer_load_dwordx2 s[58:59], s[16:19], s60 offset:24636
    s_buffer_load_dwordx2 s[58:59], s[16:19], s60 offset:32828
    s_buffer_load_dwordx2 s[58:59], s[16:19], s60 offset:41020
    s_add_u32 s60, s60, 98304
    s_barrier
    s_cmp_ge_u32 s60, s62
    s_cselect_b32 s63, 458752, 0
    s_cselect_b32 s62, -1, s62
    s_add_u32 s60, s60, s63
    s_buffer_load_dwordx2 s[58:59], s[16:19], s60 offset:60
    s_buffer_load_dwordx2 s[58:59], s[16:19], s60 offset:8252
    s_buffer_load_dwordx2 s[58:59], s[16:19], s60 offset:16444
    s_buffer_load_dwordx2 s[58:59], s[16:19], s60 offset:24636
    s_buffer_load_dwordx2 s[58:59], s[16:19], s60 offset:32828
    s_buffer_load_dwordx2 s[58:59], s[16:19], s60 offset:41020
    s_add_u32 s60, s60, 98304
    s_barrier
    s_cmp_ge_u32 s60, s62
    s_cselect_b32 s63, 458752, 0
    s_cselect_b32 s62, -1, s62
    s_add_u32 s60, s60, s63
    s_buffer_load_dwordx2 s[58:59], s[16:19], s60 offset:60
    s_buffer_load_dwordx2 s[58:59], s[16:19], s60 offset:8252
    s_buffer_load_dwordx2 s[58:59], s[16:19], s60 offset:16444
    s_buffer_load_dwordx2 s[58:59], s[16:19], s60 offset:24636
    s_buffer_load_dwordx2 s[58:59], s[16:19], s60 offset:32828
    s_buffer_load_dwordx2 s[58:59], s[16:19], s60 offset:41020
    s_add_u32 s60, s60, 98304
    s_barrier
    s_cmp_ge_u32 s60, s62
    s_cselect_b32 s63, 458752, 0
    s_cselect_b32 s62, -1, s62
    s_add_u32 s60, s60, s63
    s_buffer_load_dwordx2 s[58:59], s[16:19], s60 offset:60
    s_buffer_load_dwordx2 s[58:59], s[16:19], s60 offset:8252
    s_buffer_load_dwordx2 s[58:59], s[16:19], s60 offset:16444
    s_buffer_load_dwordx2 s[58:59], s[16:19], s60 offset:24636
    s_buffer_load_dwordx2 s[58:59], s[16:19], s60 offset:32828
    s_buffer_load_dwordx2 s[58:59], s[16:19], s60 offset:41020
    s_add_u32 s60, s60, 98304
    s_barrier
    s_cmp_ge_u32 s60, s62
    s_cselect_b32 s63, 458752, 0
    s_cselect_b32 s62, -1, s62
    s_add_u32 s60, s60, s63
    s_buffer_load_dwordx2 s[58:59], s[16:19], s60 offset:60
    s_buffer_load_dwordx2 s[58:59], s[16:19], s60 offset:8252
    s_buffer_load_dwordx2 s[58:59], s[16:19], s60 offset:16444
    s_buffer_load_dwordx2 s[58:59], s[16:19], s60 offset:24636
    s_buffer_load_dwordx2 s[58:59], s[16:19], s60 offset:32828
    s_buffer_load_dwordx2 s[58:59], s[16:19], s60 offset:41020
    s_add_u32 s60, s60, 98304
    s_barrier
    s_cmp_ge_u32 s60, s62
    s_cselect_b32 s63, 458752, 0
    s_cselect_b32 s62, -1, s62
    s_add_u32 s60, s60, s63
    s_buffer_load_dwordx2 s[58:59], s[16:19], s60 offset:60
    s_buffer_load_dwordx2 s[58:59], s[16:19], s60 offset:8252
    s_buffer_load_dwordx2 s[58:59], s[16:19], s60 offset:16444
    s_buffer_load_dwordx2 s[58:59], s[16:19], s60 offset:24636
    s_buffer_load_dwordx2 s[58:59], s[16:19], s60 offset:32828
    s_buffer_load_dwordx2 s[58:59], s[16:19], s60 offset:41020
    s_add_u32 s60, s60, 98304
    s_barrier
    s_cmp_ge_u32 s60, s62
    s_cselect_b32 s63, 458752, 0
    s_cselect_b32 s62, -1, s62
    s_add_u32 s60, s60, s63
    s_buffer_load_dwordx2 s[58:59], s[16:19], s60 offset:60
    s_buffer_load_dwordx2 s[58:59], s[16:19], s60 offset:8252
    s_buffer_load_dwordx2 s[58:59], s[16:19], s60 offset:16444
    s_buffer_load_dwordx2 s[58:59], s[16:19], s60 offset:24636
    s_buffer_load_dwordx2 s[58:59], s[16:19], s60 offset:32828
    s_buffer_load_dwordx2 s[58:59], s[16:19], s60 offset:41020
    s_add_u32 s60, s60, 98304
    s_cmp_ge_u32 s60, s62
    s_cselect_b32 s63, 458752, 0
    s_cselect_b32 s62, -1, s62
    s_add_u32 s60, s60, s63
    s_buffer_load_dwordx2 s[58:59], s[16:19], s60 offset:60
    s_buffer_load_dwordx2 s[58:59], s[16:19], s60 offset:8252
    s_buffer_load_dwordx2 s[58:59], s[16:19], s60 offset:16444
    s_buffer_load_dwordx2 s[58:59], s[16:19], s60 offset:24636
    s_buffer_load_dwordx2 s[58:59], s[16:19], s60 offset:32828
    s_buffer_load_dwordx2 s[58:59], s[16:19], s60 offset:41020
    s_add_u32 s60, s60, 98304
    s_cmp_ge_u32 s60, s62
    s_cselect_b32 s63, 458752, 0
    s_cselect_b32 s62, -1, s62
    s_add_u32 s60, s60, s63
    s_buffer_load_dwordx2 s[58:59], s[16:19], s60 offset:60
    s_buffer_load_dwordx2 s[58:59], s[16:19], s60 offset:8252
    s_buffer_load_dwordx2 s[58:59], s[16:19], s60 offset:16444
    s_buffer_load_dwordx2 s[58:59], s[16:19], s60 offset:24636
    s_buffer_load_dwordx2 s[58:59], s[16:19], s60 offset:32828
    s_buffer_load_dwordx2 s[58:59], s[16:19], s60 offset:41020
    s_add_u32 s60, s60, 98304
    s_cmp_ge_u32 s60, s62
    s_cselect_b32 s63, 458752, 0
    s_cselect_b32 s62, -1, s62
    s_add_u32 s60, s60, s63
    s_buffer_load_dwordx2 s[58:59], s[16:19], s60 offset:60
    s_buffer_load_dwordx2 s[58:59], s[16:19], s60 offset:8252
    s_buffer_load_dwordx2 s[58:59], s[16:19], s60 offset:16444
    s_buffer_load_dwordx2 s[58:59], s[16:19], s60 offset:24636
    s_buffer_load_dwordx2 s[58:59], s[16:19], s60 offset:32828
    s_buffer_load_dwordx2 s[58:59], s[16:19], s60 offset:41020
    s_add_u32 s60, s60, 98304
    s_cmp_ge_u32 s60, s62
    s_cselect_b32 s63, 458752, 0
    s_cselect_b32 s62, -1, s62
    s_add_u32 s60, s60, s63
    s_buffer_load_dwordx2 s[58:59], s[16:19], s60 offset:60
    s_buffer_load_dwordx2 s[58:59], s[16:19], s60 offset:8252
    s_buffer_load_dwordx2 s[58:59], s[16:19], s60 offset:16444
    s_buffer_load_dwordx2 s[58:59], s[16:19], s60 offset:24636
    s_buffer_load_dwordx2 s[58:59], s[16:19], s60 offset:32828
    s_buffer_load_dwordx2 s[58:59], s[16:19], s60 offset:41020
    s_add_u32 s60, s60, 98304
    s_endpgm
L3REST:
    s_mov_b64 s[16:17], s[56:57]
    s_mov_b32 s18, 1835008
    s_mov_b32 s19, 0x20000
    s_mov_b64 s[20:21], s[62:63]
    s_mov_b32 s22, 11534336
    s_mov_b32 s23, 0x20000
    s_mov_b64 s[24:25], s[58:59]
    s_mov_b32 s26, 0x200000
    s_mov_b32 s27, 0x20000
    s_mov_b64 s[28:29], s[60:61]
    s_mov_b32 s30, 256
    s_mov_b32 s31, 0x20000
    v_mov_b32 v2, 0
    s_getreg_b32 s67, hwreg(HW_REG_XCC_ID, 0, 3)
    s_andn2_b32 s66, s66, 15
    s_or_b32 s66, s66, 8
    s_or_b32 s66, s66, s67
    v_mov_b32 v3, s66
    s_cmp_eq_u32 s2, 0
    s_cselect_b32 s66, 0, 0x40000000
    buffer_store_dword v3, v2, s[28:31], s66 offen sc1
    v_mov_b32 v9, 0xffff0000
    s_barrier
    s_barrier
    buffer_load_dwordx4 v[24:27], v6, s[4:7], s64 offen offset:256
    buffer_load_dwordx4 v[28:31], v6, s[4:7], s64 offen offset:384
    s_barrier
    s_waitcnt vmcnt(3)
    v_lshlrev_b32 v48, 16, v16
    v_and_b32 v49, v9, v16
    v_mov_b32 v10, v48
    v_mov_b32 v11, v49
    v_lshlrev_b32 v50, 16, v17
    v_and_b32 v51, v9, v17
    v_add_f32 v10, v10, v50
    v_add_f32 v11, v11, v51
    v_lshlrev_b32 v52, 16, v18
    v_and_b32 v53, v9, v18
    v_add_f32 v10, v10, v52
    v_add_f32 v11, v11, v53
    v_lshlrev_b32 v54, 16, v19
    v_and_b32 v55, v9, v19
    v_add_f32 v10, v10, v54
    v_add_f32 v11, v11, v55
    v_lshlrev_b32 v56, 16, v20
    v_and_b32 v57, v9, v20
    v_add_f32 v10, v10, v56
    v_add_f32 v11, v11, v57
    v_lshlrev_b32 v58, 16, v21
    v_and_b32 v59, v9, v21
    v_add_f32 v10, v10, v58
    v_add_f32 v11, v11, v59
    v_lshlrev_b32 v60, 16, v22
    v_and_b32 v61, v9, v22
    v_add_f32 v10, v10, v60
    v_add_f32 v11, v11, v61
    v_lshlrev_b32 v62, 16, v23
    v_and_b32 v63, v9, v23
    v_add_f32 v10, v10, v62
    v_add_f32 v11, v11, v63
    s_barrier
    s_waitcnt vmcnt(0)
    v_lshlrev_b32 v64, 16, v24
    v_and_b32 v65, v9, v24
    v_add_f32 v10, v10, v64
    v_add_f32 v11, v11, v65
    v_lshlrev_b32 v66, 16, v25
    v_and_b32 v67, v9, v25
    v_add_f32 v10, v10, v66
    v_add_f32 v11, v11, v67
    v_lshlrev_b32 v68, 16, v26
    v_and_b32 v69, v9, v26
    v_add_f32 v10, v10, v68
    v_add_f32 v11, v11, v69
    v_lshlrev_b32 v70, 16, v27
    v_and_b32 v71, v9, v27
    v_add_f32 v10, v10, v70
    v_add_f32 v11, v11, v71
    v_lshlrev_b32 v72, 16, v28
    v_and_b32 v73, v9, v28
    v_add_f32 v10, v10, v72
    v_add_f32 v11, v11, v73
    v_lshlrev_b32 v74, 16, v29
    v_and_b32 v75, v9, v29
    v_add_f32 v10, v10, v74
    v_add_f32 v11, v11, v75
    v_lshlrev_b32 v76, 16, v30
    v_and_b32 v77, v9, v30
    v_add_f32 v10, v10, v76
    v_add_f32 v11, v11, v77
    v_lshlrev_b32 v78, 16, v31
    v_and_b32 v79, v9, v31
    v_add_f32 v10, v10, v78
    v_add_f32 v11, v11, v79
    s_barrier
    buffer_load_dwordx4 v[32:35], v6, s[4:7], s64 offen offset:512
    buffer_load_dwordx4 v[36:39], v6, s[4:7], s64 offen offset:640
    buffer_load_dwordx4 v[40:43], v6, s[4:7], s64 offen offset:768
    buffer_load_dwordx4 v[44:47], v6, s[4:7], s64 offen offset:896
    s_waitcnt vmcnt(2)
    v_lshlrev_b32 v80, 16, v32
    v_and_b32 v81, v9, v32
    v_add_f32 v10, v10, v80
    v_add_f32 v11, v11, v81
    v_lshlrev_b32 v82, 16, v33
    v_and_b32 v83, v9, v33
    v_add_f32 v10, v10, v82
    v_add_f32 v11, v11, v83
    v_lshlrev_b32 v84, 16, v34
    v_and_b32 v85, v9, v34
    v_add_f32 v10, v10, v84
    v_add_f32 v11, v11, v85
    v_lshlrev_b32 v86, 16, v35
    v_and_b32 v87, v9, v35
    v_add_f32 v10, v10, v86
    v_add_f32 v11, v11, v87
    v_lshlrev_b32 v88, 16, v36
    v_and_b32 v89, v9, v36
    v_add_f32 v10, v10, v88
    v_add_f32 v11, v11, v89
    v_lshlrev_b32 v90, 16, v37
    v_and_b32 v91, v9, v37
    v_add_f32 v10, v10, v90
    v_add_f32 v11, v11, v91
    v_lshlrev_b32 v92, 16, v38
    v_and_b32 v93, v9, v38
    v_add_f32 v10, v10, v92
    v_add_f32 v11, v11, v93
    v_lshlrev_b32 v94, 16, v39
    v_and_b32 v95, v9, v39
    v_add_f32 v10, v10, v94
    v_add_f32 v11, v11, v95
    s_barrier
    buffer_load_dword v3, v2, s[28:31], 0 offen sc1
    s_waitcnt vmcnt(1)
    v_lshlrev_b32 v96, 16, v40
    v_and_b32 v97, v9, v40
    v_add_f32 v10, v10, v96
    v_add_f32 v11, v11, v97
    v_lshlrev_b32 v98, 16, v41
    v_and_b32 v99, v9, v41
    v_add_f32 v10, v10, v98
    v_add_f32 v11, v11, v99
    v_lshlrev_b32 v100, 16, v42
    v_and_b32 v101, v9, v42
    v_add_f32 v10, v10, v100
    v_add_f32 v11, v11, v101
    v_lshlrev_b32 v102, 16, v43
    v_and_b32 v103, v9, v43
    v_add_f32 v10, v10, v102
    v_add_f32 v11, v11, v103
    v_lshlrev_b32 v104, 16, v44
    v_and_b32 v105, v9, v44
    v_add_f32 v10, v10, v104
    v_add_f32 v11, v11, v105
    v_lshlrev_b32 v106, 16, v45
    v_and_b32 v107, v9, v45
    v_add_f32 v10, v10, v106
    v_add_f32 v11, v11, v107
    v_lshlrev_b32 v108, 16, v46
    v_and_b32 v109, v9, v46
    v_add_f32 v10, v10, v108
    v_add_f32 v11, v11, v109
    v_lshlrev_b32 v110, 16, v47
    v_and_b32 v111, v9, v47
    v_add_f32 v10, v10, v110
    v_add_f32 v11, v11, v111
    v_add_f32 v10, v10, v11
    s_nop 1
    v_add_f32_dpp v10, v10, v10 quad_perm:[1,0,3,2] row_mask:0xf bank_mask:0xf
    s_nop 1
    v_add_f32_dpp v10, v10, v10 quad_perm:[2,3,0,1] row_mask:0xf bank_mask:0xf
    s_nop 1
    v_add_f32_dpp v10, v10, v10 row_half_mirror row_mask:0xf bank_mask:0xf
    v_mul_f32 v10, 0x3b000000, v10
    v_mov_b32 v12, 0
    v_mov_b32 v13, 0
    s_barrier
    v_sub_f32 v48, v48, v10
    v_fmac_f32 v12, v48, v48
    v_sub_f32 v49, v49, v10
    v_fmac_f32 v13, v49, v49
    v_sub_f32 v50, v50, v10
    v_fmac_f32 v12, v50, v50
    v_sub_f32 v51, v51, v10
    v_fmac_f32 v13, v51, v51
    v_sub_f32 v52, v52, v10
    v_fmac_f32 v12, v52, v52
    v_sub_f32 v53, v53, v10
    v_fmac_f32 v13, v53, v53
    v_sub_f32 v54, v54, v10
    v_fmac_f32 v12, v54, v54
    v_sub_f32 v55, v55, v10
    v_fmac_f32 v13, v55, v55
    v_sub_f32 v56, v56, v10
    v_fmac_f32 v12, v56, v56
    v_sub_f32 v57, v57, v10
    v_fmac_f32 v13, v57, v57
    v_sub_f32 v58, v58, v10
    v_fmac_f32 v12, v58, v58
    v_sub_f32 v59, v59, v10
    v_fmac_f32 v13, v59, v59
    v_sub_f32 v60, v60, v10
    v_fmac_f32 v12, v60, v60
    v_sub_f32 v61, v61, v10
    v_fmac_f32 v13, v61, v61
    v_sub_f32 v62, v62, v10
    v_fmac_f32 v12, v62, v62
    v_sub_f32 v63, v63, v10
    v_fmac_f32 v13, v63, v63
    v_sub_f32 v64, v64, v10
    v_fmac_f32 v12, v64, v64
    v_sub_f32 v65, v65, v10
    v_fmac_f32 v13, v65, v65
    v_sub_f32 v66, v66, v10
    v_fmac_f32 v12, v66, v66
    v_sub_f32 v67, v67, v10
    v_fmac_f32 v13, v67, v67
    v_sub_f32 v68, v68, v10
    v_fmac_f32 v12, v68, v68
    v_sub_f32 v69, v69, v10
    v_fmac_f32 v13, v69, v69
    v_sub_f32 v70, v70, v10
    v_fmac_f32 v12, v70, v70
    v_sub_f32 v71, v71, v10
    v_fmac_f32 v13, v71, v71
    s_barrier
    s_mov_b32 s75, 200000
    s_waitcnt vmcnt(0)
POLL1:
    v_cmp_eq_u32 vcc, 0, v3
    s_nop 1
    s_cmp_eq_u64 vcc, 0
    s_cbranch_scc1 POLLD1
    s_sleep 6
    buffer_load_dword v3, v2, s[28:31], 0 offen sc1
    s_sub_u32 s75, s75, 1
    s_cmp_lg_u32 s75, 0
    s_waitcnt vmcnt(0)
    s_cbranch_scc1 POLL1
POLLD1:
    v_mov_b32 v15, 150528
    ds_write_b32 v15, v3
    ds_write_b32 v15, v2 offset:4
    ds_write_b32 v15, v2 offset:8
    v_readfirstlane_b32 s44, v3
    v_sub_f32 v72, v72, v10
    v_fmac_f32 v12, v72, v72
    v_sub_f32 v73, v73, v10
    v_fmac_f32 v13, v73, v73
    v_sub_f32 v74, v74, v10
    v_fmac_f32 v12, v74, v74
    v_sub_f32 v75, v75, v10
    v_fmac_f32 v13, v75, v75
    v_sub_f32 v76, v76, v10
    v_fmac_f32 v12, v76, v76
    v_sub_f32 v77, v77, v10
    v_fmac_f32 v13, v77, v77
    v_sub_f32 v78, v78, v10
    v_fmac_f32 v12, v78, v78
    v_sub_f32 v79, v79, v10
    v_fmac_f32 v13, v79, v79
    v_sub_f32 v80, v80, v10
    v_fmac_f32 v12, v80, v80
    v_sub_f32 v81, v81, v10
    v_fmac_f32 v13, v81, v81
    v_sub_f32 v82, v82, v10
    v_fmac_f32 v12, v82, v82
    v_sub_f32 v83, v83, v10
    v_fmac_f32 v13, v83, v83
    v_sub_f32 v84, v84, v10
    v_fmac_f32 v12, v84, v84
    v_sub_f32 v85, v85, v10
    v_fmac_f32 v13, v85, v85
    v_sub_f32 v86, v86, v10
    v_fmac_f32 v12, v86, v86
    v_sub_f32 v87, v87, v10
    v_fmac_f32 v13, v87, v87
    v_sub_f32 v88, v88, v10
    v_fmac_f32 v12, v88, v88
    v_sub_f32 v89, v89, v10
    v_fmac_f32 v13, v89, v89
    v_sub_f32 v90, v90, v10
    v_fmac_f32 v12, v90, v90
    v_sub_f32 v91, v91, v10
    v_fmac_f32 v13, v91, v91
    s_waitcnt lgkmcnt(0)
    s_barrier
    v_sub_f32 v92, v92, v10
    v_fmac_f32 v12, v92, v92
    v_sub_f32 v93, v93, v10
    v_fmac_f32 v13, v93, v93
    v_sub_f32 v94, v94, v10
    v_fmac_f32 v12, v94, v94
    v_sub_f32 v95, v95, v10
    v_fmac_f32 v13, v95, v95
    v_sub_f32 v96, v96, v10
    v_fmac_f32 v12, v96, v96
    v_sub_f32 v97, v97, v10
    v_fmac_f32 v13, v97, v97
    v_sub_f32 v98, v98, v10
    v_fmac_f32 v12, v98, v98
    v_sub_f32 v99, v99, v10
    v_fmac_f32 v13, v99, v99
    v_sub_f32 v100, v100, v10
    v_fmac_f32 v12, v100, v100
    v_sub_f32 v101, v101, v10
    v_fmac_f32 v13, v101, v101
    v_sub_f32 v102, v102, v10
    v_fmac_f32 v12, v102, v102
    v_sub_f32 v103, v103, v10
    v_fmac_f32 v13, v103, v103
    v_sub_f32 v104, v104, v10
    v_fmac_f32 v12, v104, v104
    v_sub_f32 v105, v105, v10
    v_fmac_f32 v13, v105, v105
    v_sub_f32 v106, v106, v10
    v_fmac_f32 v12, v106, v106
    v_sub_f32 v107, v107, v10
    v_fmac_f32 v13, v107, v107
    v_sub_f32 v108, v108, v10
    v_fmac_f32 v12, v108, v108
    v_sub_f32 v109, v109, v10
    v_fmac_f32 v13, v109, v109
    v_sub_f32 v110, v110, v10
    v_fmac_f32 v12, v110, v110
    v_sub_f32 v111, v111, v10
    v_fmac_f32 v13, v111, v111
    v_add_f32 v12, v12, v13
    s_nop 1
    v_add_f32_dpp v12, v12, v12 quad_perm:[1,0,3,2] row_mask:0xf bank_mask:0xf
    s_nop 1
    v_add_f32_dpp v12, v12, v12 quad_perm:[2,3,0,1] row_mask:0xf bank_mask:0xf
    s_nop 1
    v_add_f32_dpp v12, v12, v12 row_half_mirror row_mask:0xf bank_mask:0xf
    v_mul_f32 v12, 0x3b000000, v12
    v_cvt_pk_bf16_f32 v15, v10, v12
    v_lshlrev_b32 v16, 16, v15
    v_and_b32 v12, v9, v15
    v_add_f32 v12, 0x3727c5ac, v12
    v_cvt_pk_bf16_f32 v12, v12, v12
    v_and_b32 v12, v9, v12
    v_sqrt_f32 v12, v12
    v_cmp_eq_u32 vcc, 0, v14
    v_cvt_pk_bf16_f32 v12, v12, v12
    v_and_b32 v12, v9, v12
    v_rcp_f32 v17, v12
    v_lshlrev_b32 v14, 4, v4
    v_mov_b32 v15, 0x40000000
    s_lshl_b32 s64, s37, 11
    s_add_u32 s64, s64, 10485760
    v_cndmask_b32 v14, v15, v14, vcc
    v_mov_b32 v18, v3
    v_mov_b32 v19, v3
    s_lshl_b32 s65, s38, 7
    s_add_u32 s65, s64, s65
    buffer_store_dwordx4 v[16:19], v14, s[20:23], s65 offen sc1
    s_mov_b32 s46, s2
    s_lshr_b32 s60, s45, 2
    s_lshl_b32 s60, s60, 10
    s_and_b32 s63, s45, 3
    s_lshl_b32 s63, s63, 7
    s_add_u32 s60, s60, s63
    s_and_b32 s63, s46, 1
    s_lshl_b32 s63, s63, 9
    s_add_u32 s60, s60, s63
    s_bfe_u32 s63, s2, 0x20001
    s_mul_i32 s62, s63, 458752
    s_add_u32 s60, s60, 49152
    s_add_u32 s62, s62, s60
    s_barrier
    s_barrier
    s_cmp_ge_u32 s60, s62
    s_cselect_b32 s63, 458752, 0
    s_cselect_b32 s62, -1, s62
    s_add_u32 s60, s60, s63
    s_buffer_load_dwordx2 s[58:59], s[16:19], s60 offset:60
    s_buffer_load_dwordx2 s[58:59], s[16:19], s60 offset:8252
    s_buffer_load_dwordx2 s[58:59], s[16:19], s60 offset:16444
    s_buffer_load_dwordx2 s[58:59], s[16:19], s60 offset:24636
    s_buffer_load_dwordx2 s[58:59], s[16:19], s60 offset:32828
    s_buffer_load_dwordx2 s[58:59], s[16:19], s60 offset:41020
    s_add_u32 s60, s60, 98304
    s_barrier
    s_cmp_ge_u32 s60, s62
    s_cselect_b32 s63, 458752, 0
    s_cselect_b32 s62, -1, s62
    s_add_u32 s60, s60, s63
    s_buffer_load_dwordx2 s[58:59], s[16:19], s60 offset:60
    s_buffer_load_dwordx2 s[58:59], s[16:19], s60 offset:8252
    s_buffer_load_dwordx2 s[58:59], s[16:19], s60 offset:16444
    s_buffer_load_dwordx2 s[58:59], s[16:19], s60 offset:24636
    s_buffer_load_dwordx2 s[58:59], s[16:19], s60 offset:32828
    s_buffer_load_dwordx2 s[58:59], s[16:19], s60 offset:41020
    s_add_u32 s60, s60, 98304
    s_barrier
    s_cmp_ge_u32 s60, s62
    s_cselect_b32 s63, 458752, 0
    s_cselect_b32 s62, -1, s62
    s_add_u32 s60, s60, s63
    s_buffer_load_dwordx2 s[58:59], s[16:19], s60 offset:60
    s_buffer_load_dwordx2 s[58:59], s[16:19], s60 offset:8252
    s_buffer_load_dwordx2 s[58:59], s[16:19], s60 offset:16444
    s_buffer_load_dwordx2 s[58:59], s[16:19], s60 offset:24636
    s_buffer_load_dwordx2 s[58:59], s[16:19], s60 offset:32828
    s_buffer_load_dwordx2 s[58:59], s[16:19], s60 offset:41020
    s_add_u32 s60, s60, 98304
    s_barrier
    s_cmp_ge_u32 s60, s62
    s_cselect_b32 s63, 458752, 0
    s_cselect_b32 s62, -1, s62
    s_add_u32 s60, s60, s63
    s_buffer_load_dwordx2 s[58:59], s[16:19], s60 offset:60
    s_buffer_load_dwordx2 s[58:59], s[16:19], s60 offset:8252
    s_buffer_load_dwordx2 s[58:59], s[16:19], s60 offset:16444
    s_buffer_load_dwordx2 s[58:59], s[16:19], s60 offset:24636
    s_buffer_load_dwordx2 s[58:59], s[16:19], s60 offset:32828
    s_buffer_load_dwordx2 s[58:59], s[16:19], s60 offset:41020
    s_add_u32 s60, s60, 98304
    s_barrier
    s_cmp_ge_u32 s60, s62
    s_cselect_b32 s63, 458752, 0
    s_cselect_b32 s62, -1, s62
    s_add_u32 s60, s60, s63
    s_buffer_load_dwordx2 s[58:59], s[16:19], s60 offset:60
    s_buffer_load_dwordx2 s[58:59], s[16:19], s60 offset:8252
    s_buffer_load_dwordx2 s[58:59], s[16:19], s60 offset:16444
    s_buffer_load_dwordx2 s[58:59], s[16:19], s60 offset:24636
    s_buffer_load_dwordx2 s[58:59], s[16:19], s60 offset:32828
    s_buffer_load_dwordx2 s[58:59], s[16:19], s60 offset:41020
    s_add_u32 s60, s60, 98304
    s_barrier
    s_cmp_ge_u32 s60, s62
    s_cselect_b32 s63, 458752, 0
    s_cselect_b32 s62, -1, s62
    s_add_u32 s60, s60, s63
    s_buffer_load_dwordx2 s[58:59], s[16:19], s60 offset:60
    s_buffer_load_dwordx2 s[58:59], s[16:19], s60 offset:8252
    s_buffer_load_dwordx2 s[58:59], s[16:19], s60 offset:16444
    s_buffer_load_dwordx2 s[58:59], s[16:19], s60 offset:24636
    s_buffer_load_dwordx2 s[58:59], s[16:19], s60 offset:32828
    s_buffer_load_dwordx2 s[58:59], s[16:19], s60 offset:41020
    s_add_u32 s60, s60, 98304
    s_barrier
    s_cmp_ge_u32 s60, s62
    s_cselect_b32 s63, 458752, 0
    s_cselect_b32 s62, -1, s62
    s_add_u32 s60, s60, s63
    s_buffer_load_dwordx2 s[58:59], s[16:19], s60 offset:60
    s_buffer_load_dwordx2 s[58:59], s[16:19], s60 offset:8252
    s_buffer_load_dwordx2 s[58:59], s[16:19], s60 offset:16444
    s_buffer_load_dwordx2 s[58:59], s[16:19], s60 offset:24636
    s_buffer_load_dwordx2 s[58:59], s[16:19], s60 offset:32828
    s_buffer_load_dwordx2 s[58:59], s[16:19], s60 offset:41020
    s_add_u32 s60, s60, 98304
    s_cmp_ge_u32 s60, s62
    s_cselect_b32 s63, 458752, 0
    s_cselect_b32 s62, -1, s62
    s_add_u32 s60, s60, s63
    s_buffer_load_dwordx2 s[58:59], s[16:19], s60 offset:60
    s_buffer_load_dwordx2 s[58:59], s[16:19], s60 offset:8252
    s_buffer_load_dwordx2 s[58:59], s[16:19], s60 offset:16444
    s_buffer_load_dwordx2 s[58:59], s[16:19], s60 offset:24636
    s_buffer_load_dwordx2 s[58:59], s[16:19], s60 offset:32828
    s_buffer_load_dwordx2 s[58:59], s[16:19], s60 offset:41020
    s_add_u32 s60, s60, 98304
    s_cmp_ge_u32 s60, s62
    s_cselect_b32 s63, 458752, 0
    s_cselect_b32 s62, -1, s62
    s_add_u32 s60, s60, s63
    s_buffer_load_dwordx2 s[58:59], s[16:19], s60 offset:60
    s_buffer_load_dwordx2 s[58:59], s[16:19], s60 offset:8252
    s_buffer_load_dwordx2 s[58:59], s[16:19], s60 offset:16444
    s_buffer_load_dwordx2 s[58:59], s[16:19], s60 offset:24636
    s_buffer_load_dwordx2 s[58:59], s[16:19], s60 offset:32828
    s_buffer_load_dwordx2 s[58:59], s[16:19], s60 offset:41020
    s_add_u32 s60, s60, 98304
    s_cmp_ge_u32 s60, s62
    s_cselect_b32 s63, 458752, 0
    s_cselect_b32 s62, -1, s62
    s_add_u32 s60, s60, s63
    s_buffer_load_dwordx2 s[58:59], s[16:19], s60 offset:60
    s_buffer_load_dwordx2 s[58:59], s[16:19], s60 offset:8252
    s_buffer_load_dwordx2 s[58:59], s[16:19], s60 offset:16444
    s_buffer_load_dwordx2 s[58:59], s[16:19], s60 offset:24636
    s_buffer_load_dwordx2 s[58:59], s[16:19], s60 offset:32828
    s_buffer_load_dwordx2 s[58:59], s[16:19], s60 offset:41020
    s_add_u32 s60, s60, 98304
    s_cmp_ge_u32 s60, s62
    s_cselect_b32 s63, 458752, 0
    s_cselect_b32 s62, -1, s62
    s_add_u32 s60, s60, s63
    s_buffer_load_dwordx2 s[58:59], s[16:19], s60 offset:60
    s_buffer_load_dwordx2 s[58:59], s[16:19], s60 offset:8252
    s_buffer_load_dwordx2 s[58:59], s[16:19], s60 offset:16444
    s_buffer_load_dwordx2 s[58:59], s[16:19], s60 offset:24636
    s_buffer_load_dwordx2 s[58:59], s[16:19], s60 offset:32828
    s_buffer_load_dwordx2 s[58:59], s[16:19], s60 offset:41020
    s_add_u32 s60, s60, 98304
    s_endpgm
.p2align 12
CGLU:
    s_barrier
    ds_read_b64_tr_b16 v[64:65], v114 offset:0
    ds_read_b64_tr_b16 v[66:67], v114 offset:2048
    ds_read_b128 v[0:3], v112 offset:0
    ds_read_b64_tr_b16 v[68:69], v115 offset:0
    ds_read_b64_tr_b16 v[70:71], v115 offset:2048
    ds_read_b64_tr_b16 v[72:73], v114 offset:1024
    ds_read_b64_tr_b16 v[74:75], v114 offset:3072
    ds_read_b64_tr_b16 v[76:77], v115 offset:1024
    ds_read_b64_tr_b16 v[78:79], v115 offset:3072
    ds_read_b128 v[4:7], v112 offset:2048
    ds_read_b128 v[8:11], v112 offset:4096
    ds_read_b128 v[12:15], v112 offset:6144
    s_mov_b32 s64, 8
    s_mov_b32 s66, 49152
    s_mov_b32 s67, 0xfffe8000
.p2align 3
MAING:
    s_waitcnt lgkmcnt(10)
    s_waitcnt lgkmcnt(9)
    v_mfma_f32_16x16x32_bf16 v[128:131], v[64:67], v[0:3], v[128:131]
    s_waitcnt lgkmcnt(7)
    v_mfma_f32_16x16x32_bf16 v[132:135], v[68:71], v[0:3], v[132:135]
    ds_read_b128 v[16:19], v112 offset:8192
    s_waitcnt lgkmcnt(6)
    v_mfma_f32_16x16x32_bf16 v[136:139], v[72:75], v[0:3], v[136:139]
    s_waitcnt lgkmcnt(4)
    v_mfma_f32_16x16x32_bf16 v[140:143], v[76:79], v[0:3], v[140:143]
    ds_read_b128 v[20:23], v112 offset:10240
    s_waitcnt lgkmcnt(4)
    v_mfma_f32_16x16x32_bf16 v[144:147], v[64:67], v[4:7], v[144:147]
    v_mfma_f32_16x16x32_bf16 v[148:151], v[68:71], v[4:7], v[148:151]
    ds_read_b128 v[24:27], v112 offset:12288
    v_mfma_f32_16x16x32_bf16 v[152:155], v[72:75], v[4:7], v[152:155]
    v_mfma_f32_16x16x32_bf16 v[156:159], v[76:79], v[4:7], v[156:159]
    ds_read_b128 v[28:31], v112 offset:14336
    s_waitcnt lgkmcnt(5)
    v_mfma_f32_16x16x32_bf16 v[160:163], v[64:67], v[8:11], v[160:163]
    v_mfma_f32_16x16x32_bf16 v[164:167], v[68:71], v[8:11], v[164:167]
    s_cmp_eq_u32 s66, 98304
    s_cselect_b32 s65, s67, 49152
    v_mfma_f32_16x16x32_bf16 v[168:171], v[72:75], v[8:11], v[168:171]
    s_add_u32 s66, s66, s65
    s_sub_u32 s64, s64, 1
    v_mfma_f32_16x16x32_bf16 v[172:175], v[76:79], v[8:11], v[172:175]
    s_waitcnt lgkmcnt(4)
    v_mfma_f32_16x16x32_bf16 v[176:179], v[64:67], v[12:15], v[176:179]
    v_mfma_f32_16x16x32_bf16 v[180:183], v[68:71], v[12:15], v[180:183]
    v_mfma_f32_16x16x32_bf16 v[184:187], v[72:75], v[12:15], v[184:187]
    v_mfma_f32_16x16x32_bf16 v[188:191], v[76:79], v[12:15], v[188:191]
    s_waitcnt lgkmcnt(0)
    v_mfma_f32_16x16x32_bf16 v[192:195], v[64:67], v[16:19], v[192:195]
    s_barrier
    v_mfma_f32_16x16x32_bf16 v[196:199], v[68:71], v[16:19], v[196:199]
    ds_read_b64_tr_b16 v[80:81], v114 offset:16384
    v_mfma_f32_16x16x32_bf16 v[200:203], v[72:75], v[16:19], v[200:203]
    ds_read_b64_tr_b16 v[82:83], v114 offset:18432
    v_mfma_f32_16x16x32_bf16 v[204:207], v[76:79], v[16:19], v[204:207]
    ds_read_b128 v[0:3], v113 offset:0
    v_mfma_f32_16x16x32_bf16 v[208:211], v[64:67], v[20:23], v[208:211]
    ds_read_b64_tr_b16 v[84:85], v115 offset:16384
    v_mfma_f32_16x16x32_bf16 v[212:215], v[68:71], v[20:23], v[212:215]
    ds_read_b64_tr_b16 v[86:87], v115 offset:18432
    v_mfma_f32_16x16x32_bf16 v[216:219], v[72:75], v[20:23], v[216:219]
    ds_read_b64_tr_b16 v[88:89], v114 offset:17408
    v_mfma_f32_16x16x32_bf16 v[220:223], v[76:79], v[20:23], v[220:223]
    ds_read_b64_tr_b16 v[90:91], v114 offset:19456
    v_mfma_f32_16x16x32_bf16 v[224:227], v[64:67], v[24:27], v[224:227]
    ds_read_b64_tr_b16 v[92:93], v115 offset:17408
    v_mfma_f32_16x16x32_bf16 v[228:231], v[68:71], v[24:27], v[228:231]
    ds_read_b64_tr_b16 v[94:95], v115 offset:19456
    v_mfma_f32_16x16x32_bf16 v[232:235], v[72:75], v[24:27], v[232:235]
    ds_read_b128 v[4:7], v113 offset:2048
    v_mfma_f32_16x16x32_bf16 v[236:239], v[76:79], v[24:27], v[236:239]
    ds_read_b128 v[8:11], v113 offset:4096
    v_mfma_f32_16x16x32_bf16 v[240:243], v[64:67], v[28:31], v[240:243]
    ds_read_b128 v[12:15], v113 offset:6144
    v_mfma_f32_16x16x32_bf16 v[244:247], v[68:71], v[28:31], v[244:247]
    v_mfma_f32_16x16x32_bf16 v[248:251], v[72:75], v[28:31], v[248:251]
    v_mfma_f32_16x16x32_bf16 v[252:255], v[76:79], v[28:31], v[252:255]
    s_cmp_eq_u32 s64, 0
    s_cbranch_scc1 LASTG
    s_waitcnt lgkmcnt(10)
    s_waitcnt lgkmcnt(9)
    v_mfma_f32_16x16x32_bf16 v[128:131], v[80:83], v[0:3], v[128:131]
    s_waitcnt lgkmcnt(7)
    v_mfma_f32_16x16x32_bf16 v[132:135], v[84:87], v[0:3], v[132:135]
    ds_read_b128 v[16:19], v113 offset:8192
    s_waitcnt lgkmcnt(6)
    v_mfma_f32_16x16x32_bf16 v[136:139], v[88:91], v[0:3], v[136:139]
    s_waitcnt lgkmcnt(4)
    v_mfma_f32_16x16x32_bf16 v[140:143], v[92:95], v[0:3], v[140:143]
    ds_read_b128 v[20:23], v113 offset:10240
    s_waitcnt lgkmcnt(4)
    v_mfma_f32_16x16x32_bf16 v[144:147], v[80:83], v[4:7], v[144:147]
    v_mfma_f32_16x16x32_bf16 v[148:151], v[84:87], v[4:7], v[148:151]
    ds_read_b128 v[24:27], v113 offset:12288
    v_mfma_f32_16x16x32_bf16 v[152:155], v[88:91], v[4:7], v[152:155]
    v_mfma_f32_16x16x32_bf16 v[156:159], v[92:95], v[4:7], v[156:159]
    ds_read_b128 v[28:31], v113 offset:14336
    s_waitcnt lgkmcnt(5)
    v_mfma_f32_16x16x32_bf16 v[160:163], v[80:83], v[8:11], v[160:163]
    v_mfma_f32_16x16x32_bf16 v[164:167], v[84:87], v[8:11], v[164:167]
    v_add_u32 v112, s65, v112
    v_add_u32 v113, s65, v113
    v_mfma_f32_16x16x32_bf16 v[168:171], v[88:91], v[8:11], v[168:171]
    v_add_u32 v114, s65, v114
    v_add_u32 v115, s65, v115
    v_mfma_f32_16x16x32_bf16 v[172:175], v[92:95], v[8:11], v[172:175]
    s_waitcnt lgkmcnt(4)
    v_mfma_f32_16x16x32_bf16 v[176:179], v[80:83], v[12:15], v[176:179]
    v_mfma_f32_16x16x32_bf16 v[180:183], v[84:87], v[12:15], v[180:183]
    v_mfma_f32_16x16x32_bf16 v[184:187], v[88:91], v[12:15], v[184:187]
    v_mfma_f32_16x16x32_bf16 v[188:191], v[92:95], v[12:15], v[188:191]
    s_waitcnt lgkmcnt(0)
    v_mfma_f32_16x16x32_bf16 v[192:195], v[80:83], v[16:19], v[192:195]
    s_barrier
    v_mfma_f32_16x16x32_bf16 v[196:199], v[84:87], v[16:19], v[196:199]
    ds_read_b64_tr_b16 v[64:65], v114 offset:0
    v_mfma_f32_16x16x32_bf16 v[200:203], v[88:91], v[16:19], v[200:203]
    ds_read_b64_tr_b16 v[66:67], v114 offset:2048
    v_mfma_f32_16x16x32_bf16 v[204:207], v[92:95], v[16:19], v[204:207]
    ds_read_b128 v[0:3], v112 offset:0
    v_mfma_f32_16x16x32_bf16 v[208:211], v[80:83], v[20:23], v[208:211]
    ds_read_b64_tr_b16 v[68:69], v115 offset:0
    v_mfma_f32_16x16x32_bf16 v[212:215], v[84:87], v[20:23], v[212:215]
    ds_read_b64_tr_b16 v[70:71], v115 offset:2048
    v_mfma_f32_16x16x32_bf16 v[216:219], v[88:91], v[20:23], v[216:219]
    ds_read_b64_tr_b16 v[72:73], v114 offset:1024
    v_mfma_f32_16x16x32_bf16 v[220:223], v[92:95], v[20:23], v[220:223]
    ds_read_b64_tr_b16 v[74:75], v114 offset:3072
    v_mfma_f32_16x16x32_bf16 v[224:227], v[80:83], v[24:27], v[224:227]
    ds_read_b64_tr_b16 v[76:77], v115 offset:1024
    v_mfma_f32_16x16x32_bf16 v[228:231], v[84:87], v[24:27], v[228:231]
    ds_read_b64_tr_b16 v[78:79], v115 offset:3072
    v_mfma_f32_16x16x32_bf16 v[232:235], v[88:91], v[24:27], v[232:235]
    ds_read_b128 v[4:7], v112 offset:2048
    v_mfma_f32_16x16x32_bf16 v[236:239], v[92:95], v[24:27], v[236:239]
    ds_read_b128 v[8:11], v112 offset:4096
    v_mfma_f32_16x16x32_bf16 v[240:243], v[80:83], v[28:31], v[240:243]
    ds_read_b128 v[12:15], v112 offset:6144
    v_mfma_f32_16x16x32_bf16 v[244:247], v[84:87], v[28:31], v[244:247]
    v_mfma_f32_16x16x32_bf16 v[248:251], v[88:91], v[28:31], v[248:251]
    v_mfma_f32_16x16x32_bf16 v[252:255], v[92:95], v[28:31], v[252:255]
    s_branch MAING
LASTG:
    s_waitcnt lgkmcnt(10)
    s_waitcnt lgkmcnt(9)
    v_mfma_f32_16x16x32_bf16 v[128:131], v[80:83], v[0:3], v[128:131]
    ds_read_b32 v96, v116
    s_waitcnt lgkmcnt(8)
    v_mfma_f32_16x16x32_bf16 v[132:135], v[84:87], v[0:3], v[132:135]
    ds_read_b128 v[16:19], v113 offset:8192
    s_waitcnt lgkmcnt(7)
    v_mfma_f32_16x16x32_bf16 v[136:139], v[88:91], v[0:3], v[136:139]
    s_waitcnt lgkmcnt(5)
    v_mfma_f32_16x16x32_bf16 v[140:143], v[92:95], v[0:3], v[140:143]
    ds_read_b128 v[20:23], v113 offset:10240
    s_waitcnt lgkmcnt(5)
    v_mfma_f32_16x16x32_bf16 v[144:147], v[80:83], v[4:7], v[144:147]
    v_mfma_f32_16x16x32_bf16 v[148:151], v[84:87], v[4:7], v[148:151]
    ds_read_b128 v[24:27], v113 offset:12288
    v_mfma_f32_16x16x32_bf16 v[152:155], v[88:91], v[4:7], v[152:155]
    v_mfma_f32_16x16x32_bf16 v[156:159], v[92:95], v[4:7], v[156:159]
    ds_read_b128 v[28:31], v113 offset:14336
    s_waitcnt lgkmcnt(6)
    v_mfma_f32_16x16x32_bf16 v[160:163], v[80:83], v[8:11], v[160:163]
    s_waitcnt lgkmcnt(4)
    v_readfirstlane_b32 s44, v96
    v_mfma_f32_16x16x32_bf16 v[164:167], v[84:87], v[8:11], v[164:167]
    v_and_b32 v100, 31, v117
    v_mfma_f32_16x16x32_bf16 v[168:171], v[88:91], v[8:11], v[168:171]
    v_lshrrev_b32 v101, 5, v117
    v_mfma_f32_16x16x32_bf16 v[172:175], v[92:95], v[8:11], v[172:175]
    v_lshlrev_b32 v115, 16, v100
    v_mfma_f32_16x16x32_bf16 v[176:179], v[80:83], v[12:15], v[176:179]
    v_lshl_add_u32 v115, v101, 5, v115
    v_mfma_f32_16x16x32_bf16 v[180:183], v[84:87], v[12:15], v[180:183]
    v_mfma_f32_16x16x32_bf16 v[184:187], v[88:91], v[12:15], v[184:187]
    v_mfma_f32_16x16x32_bf16 v[188:191], v[92:95], v[12:15], v[188:191]
    s_waitcnt lgkmcnt(0)
    v_mfma_f32_16x16x32_bf16 v[192:195], v[80:83], v[16:19], v[192:195]
    s_barrier
    v_mfma_f32_16x16x32_bf16 v[196:199], v[84:87], v[16:19], v[196:199]
    ds_read_b64 v[32:33], v120 offset:0
    v_mfma_f32_16x16x32_bf16 v[200:203], v[88:91], v[16:19], v[200:203]
    ds_read_b64 v[34:35], v120 offset:128
    v_mfma_f32_16x16x32_bf16 v[204:207], v[92:95], v[16:19], v[204:207]
    ds_read_b64 v[36:37], v120 offset:256
    v_mfma_f32_16x16x32_bf16 v[208:211], v[80:83], v[20:23], v[208:211]
    ds_read_b64 v[38:39], v120 offset:384
    v_mfma_f32_16x16x32_bf16 v[212:215], v[84:87], v[20:23], v[212:215]
    ds_read_b64 v[40:41], v120 offset:512
    v_mfma_f32_16x16x32_bf16 v[216:219], v[88:91], v[20:23], v[216:219]
    ds_read_b64 v[42:43], v120 offset:640
    v_mfma_f32_16x16x32_bf16 v[220:223], v[92:95], v[20:23], v[220:223]
    ds_read_b64 v[44:45], v120 offset:768
    v_mfma_f32_16x16x32_bf16 v[224:227], v[80:83], v[24:27], v[224:227]
    ds_read_b64 v[46:47], v120 offset:896
    v_mfma_f32_16x16x32_bf16 v[228:231], v[84:87], v[24:27], v[228:231]
    ds_read_b128 v[48:51], v119 offset:0
    v_mfma_f32_16x16x32_bf16 v[232:235], v[88:91], v[24:27], v[232:235]
    ds_read_b128 v[52:55], v119 offset:64
    v_mfma_f32_16x16x32_bf16 v[236:239], v[92:95], v[24:27], v[236:239]
    ds_read_b128 v[56:59], v119 offset:512
    v_mfma_f32_16x16x32_bf16 v[240:243], v[80:83], v[28:31], v[240:243]
    ds_read_b128 v[60:63], v119 offset:576
    v_mfma_f32_16x16x32_bf16 v[244:247], v[84:87], v[28:31], v[244:247]
    ds_read_b128 v[96:99], v116
    v_mfma_f32_16x16x32_bf16 v[248:251], v[88:91], v[28:31], v[248:251]
    v_mfma_f32_16x16x32_bf16 v[252:255], v[92:95], v[28:31], v[252:255]
    v_and_b32 v102, 15, v117
    v_bfe_u32 v103, v117, 4, 1
    v_lshlrev_b32 v102, 4, v102
    v_lshl_add_u32 v102, v103, 9, v102
    v_lshrrev_b32 v103, 5, v117
    v_mul_u32_u24 v103, 57344, v103
    v_add_u32 v102, v102, v103
    s_mov_b32 s66, 1.0
    s_mov_b32 s67, 1.0
    buffer_load_dwordx4 v[80:83], v115, s[4:7], s56 offen
    buffer_load_dwordx4 v[84:87], v115, s[4:7], s56 offen offset:16
    s_waitcnt lgkmcnt(0)
    v_readfirstlane_b32 s59, v99
    v_mul_f32 v33, 0xbfb8aa3b, v33
    v_mul_f32 v35, 0xbfb8aa3b, v35
    v_mul_f32 v37, 0xbfb8aa3b, v37
    v_mul_f32 v39, 0xbfb8aa3b, v39
    v_mul_f32 v41, 0xbfb8aa3b, v41
    v_mul_f32 v43, 0xbfb8aa3b, v43
    v_mul_f32 v45, 0xbfb8aa3b, v45
    v_mul_f32 v47, 0xbfb8aa3b, v47
.p2align 3
    v_pk_fma_f32 v[128:129], v[48:49], v[32:33], v[128:129] op_sel_hi:[1,0,1] neg_lo:[0,1,0] neg_hi:[0,1,0]
    v_pk_fma_f32 v[130:131], v[50:51], v[32:33], v[130:131] op_sel_hi:[1,0,1] neg_lo:[0,1,0] neg_hi:[0,1,0]
    v_pk_fma_f32 v[132:133], v[52:53], v[32:33], v[132:133] op_sel_hi:[1,0,1] neg_lo:[0,1,0] neg_hi:[0,1,0]
    v_pk_fma_f32 v[134:135], v[54:55], v[32:33], v[134:135] op_sel_hi:[1,0,1] neg_lo:[0,1,0] neg_hi:[0,1,0]
    v_pk_mul_f32 v[128:129], v[128:129], v[32:33] op_sel:[0,1] op_sel_hi:[1,1]
    v_pk_mul_f32 v[130:131], v[130:131], v[32:33] op_sel:[0,1] op_sel_hi:[1,1]
    v_pk_mul_f32 v[132:133], v[132:133], v[32:33] op_sel:[0,1] op_sel_hi:[1,1]
    v_pk_mul_f32 v[134:135], v[134:135], v[32:33] op_sel:[0,1] op_sel_hi:[1,1]
    v_exp_f32 v128, v128
    v_exp_f32 v129, v129
    v_exp_f32 v130, v130
    v_exp_f32 v131, v131
    v_exp_f32 v132, v132
    v_exp_f32 v133, v133
    v_exp_f32 v134, v134
    v_exp_f32 v135, v135
    v_pk_add_f32 v[128:129], v[128:129], s[66:67]
    v_pk_add_f32 v[130:131], v[130:131], s[66:67]
    v_pk_add_f32 v[132:133], v[132:133], s[66:67]
    v_pk_add_f32 v[134:135], v[134:135], s[66:67]
    v_rcp_f32 v128, v128
    v_rcp_f32 v129, v129
    v_rcp_f32 v130, v130
    v_rcp_f32 v131, v131
    v_rcp_f32 v132, v132
    v_rcp_f32 v133, v133
    v_rcp_f32 v134, v134
    v_rcp_f32 v135, v135
    v_pk_fma_f32 v[136:137], v[56:57], v[32:33], v[136:137] op_sel_hi:[1,0,1] neg_lo:[0,1,0] neg_hi:[0,1,0]
    v_pk_fma_f32 v[138:139], v[58:59], v[32:33], v[138:139] op_sel_hi:[1,0,1] neg_lo:[0,1,0] neg_hi:[0,1,0]
    v_pk_fma_f32 v[140:141], v[60:61], v[32:33], v[140:141] op_sel_hi:[1,0,1] neg_lo:[0,1,0] neg_hi:[0,1,0]
    v_pk_fma_f32 v[142:143], v[62:63], v[32:33], v[142:143] op_sel_hi:[1,0,1] neg_lo:[0,1,0] neg_hi:[0,1,0]
    v_pk_mul_f32 v[136:137], v[136:137], v[128:129]
    v_pk_mul_f32 v[138:139], v[138:139], v[130:131]
    v_pk_mul_f32 v[140:141], v[140:141], v[132:133]
    v_pk_mul_f32 v[142:143], v[142:143], v[134:135]
    v_cvt_pk_bf16_f32 v0, v136, v137
    v_cvt_pk_bf16_f32 v1, v138, v139
    v_cvt_pk_bf16_f32 v2, v140, v141
    v_cvt_pk_bf16_f32 v3, v142, v143
    s_add_u32 s65, s62, 0
    buffer_store_dwordx4 v[0:3], v102, s[20:23], s65 offen sc1
    v_pk_fma_f32 v[144:145], v[48:49], v[34:35], v[144:145] op_sel_hi:[1,0,1] neg_lo:[0,1,0] neg_hi:[0,1,0]
    v_pk_fma_f32 v[146:147], v[50:51], v[34:35], v[146:147] op_sel_hi:[1,0,1] neg_lo:[0,1,0] neg_hi:[0,1,0]
    v_pk_fma_f32 v[148:149], v[52:53], v[34:35], v[148:149] op_sel_hi:[1,0,1] neg_lo:[0,1,0] neg_hi:[0,1,0]
    v_pk_fma_f32 v[150:151], v[54:55], v[34:35], v[150:151] op_sel_hi:[1,0,1] neg_lo:[0,1,0] neg_hi:[0,1,0]
    v_pk_mul_f32 v[144:145], v[144:145], v[34:35] op_sel:[0,1] op_sel_hi:[1,1]
    v_pk_mul_f32 v[146:147], v[146:147], v[34:35] op_sel:[0,1] op_sel_hi:[1,1]
    v_pk_mul_f32 v[148:149], v[148:149], v[34:35] op_sel:[0,1] op_sel_hi:[1,1]
    v_pk_mul_f32 v[150:151], v[150:151], v[34:35] op_sel:[0,1] op_sel_hi:[1,1]
    v_exp_f32 v144, v144
    v_exp_f32 v145, v145
    v_exp_f32 v146, v146
    v_exp_f32 v147, v147
    v_exp_f32 v148, v148
    v_exp_f32 v149, v149
    v_exp_f32 v150, v150
    v_exp_f32 v151, v151
    v_pk_add_f32 v[144:145], v[144:145], s[66:67]
    v_pk_add_f32 v[146:147], v[146:147], s[66:67]
    v_pk_add_f32 v[148:149], v[148:149], s[66:67]
    v_pk_add_f32 v[150:151], v[150:151], s[66:67]
    v_rcp_f32 v144, v144
    v_rcp_f32 v145, v145
    v_rcp_f32 v146, v146
    v_rcp_f32 v147, v147
    v_rcp_f32 v148, v148
    v_rcp_f32 v149, v149
    v_rcp_f32 v150, v150
    v_rcp_f32 v151, v151
    v_pk_fma_f32 v[152:153], v[56:57], v[34:35], v[152:153] op_sel_hi:[1,0,1] neg_lo:[0,1,0] neg_hi:[0,1,0]
    v_pk_fma_f32 v[154:155], v[58:59], v[34:35], v[154:155] op_sel_hi:[1,0,1] neg_lo:[0,1,0] neg_hi:[0,1,0]
    v_pk_fma_f32 v[156:157], v[60:61], v[34:35], v[156:157] op_sel_hi:[1,0,1] neg_lo:[0,1,0] neg_hi:[0,1,0]
    v_pk_fma_f32 v[158:159], v[62:63], v[34:35], v[158:159] op_sel_hi:[1,0,1] neg_lo:[0,1,0] neg_hi:[0,1,0]
    v_pk_mul_f32 v[152:153], v[152:153], v[144:145]
    v_pk_mul_f32 v[154:155], v[154:155], v[146:147]
    v_pk_mul_f32 v[156:157], v[156:157], v[148:149]
    v_pk_mul_f32 v[158:159], v[158:159], v[150:151]
    v_cvt_pk_bf16_f32 v4, v152, v153
    v_cvt_pk_bf16_f32 v5, v154, v155
    v_cvt_pk_bf16_f32 v6, v156, v157
    v_cvt_pk_bf16_f32 v7, v158, v159
    s_add_u32 s65, s62, 256
    buffer_store_dwordx4 v[4:7], v102, s[20:23], s65 offen sc1
    v_pk_fma_f32 v[160:161], v[48:49], v[36:37], v[160:161] op_sel_hi:[1,0,1] neg_lo:[0,1,0] neg_hi:[0,1,0]
    v_pk_fma_f32 v[162:163], v[50:51], v[36:37], v[162:163] op_sel_hi:[1,0,1] neg_lo:[0,1,0] neg_hi:[0,1,0]
    v_pk_fma_f32 v[164:165], v[52:53], v[36:37], v[164:165] op_sel_hi:[1,0,1] neg_lo:[0,1,0] neg_hi:[0,1,0]
    v_pk_fma_f32 v[166:167], v[54:55], v[36:37], v[166:167] op_sel_hi:[1,0,1] neg_lo:[0,1,0] neg_hi:[0,1,0]
    v_pk_mul_f32 v[160:161], v[160:161], v[36:37] op_sel:[0,1] op_sel_hi:[1,1]
    v_pk_mul_f32 v[162:163], v[162:163], v[36:37] op_sel:[0,1] op_sel_hi:[1,1]
    v_pk_mul_f32 v[164:165], v[164:165], v[36:37] op_sel:[0,1] op_sel_hi:[1,1]
    v_pk_mul_f32 v[166:167], v[166:167], v[36:37] op_sel:[0,1] op_sel_hi:[1,1]
    v_exp_f32 v160, v160
    v_exp_f32 v161, v161
    v_exp_f32 v162, v162
    v_exp_f32 v163, v163
    v_exp_f32 v164, v164
    v_exp_f32 v165, v165
    v_exp_f32 v166, v166
    v_exp_f32 v167, v167
    v_pk_add_f32 v[160:161], v[160:161], s[66:67]
    v_pk_add_f32 v[162:163], v[162:163], s[66:67]
    v_pk_add_f32 v[164:165], v[164:165], s[66:67]
    v_pk_add_f32 v[166:167], v[166:167], s[66:67]
    v_rcp_f32 v160, v160
    v_rcp_f32 v161, v161
    v_rcp_f32 v162, v162
    v_rcp_f32 v163, v163
    v_rcp_f32 v164, v164
    v_rcp_f32 v165, v165
    v_rcp_f32 v166, v166
    v_rcp_f32 v167, v167
    v_pk_fma_f32 v[168:169], v[56:57], v[36:37], v[168:169] op_sel_hi:[1,0,1] neg_lo:[0,1,0] neg_hi:[0,1,0]
    v_pk_fma_f32 v[170:171], v[58:59], v[36:37], v[170:171] op_sel_hi:[1,0,1] neg_lo:[0,1,0] neg_hi:[0,1,0]
    v_pk_fma_f32 v[172:173], v[60:61], v[36:37], v[172:173] op_sel_hi:[1,0,1] neg_lo:[0,1,0] neg_hi:[0,1,0]
    v_pk_fma_f32 v[174:175], v[62:63], v[36:37], v[174:175] op_sel_hi:[1,0,1] neg_lo:[0,1,0] neg_hi:[0,1,0]
    v_pk_mul_f32 v[168:169], v[168:169], v[160:161]
    v_pk_mul_f32 v[170:171], v[170:171], v[162:163]
    v_pk_mul_f32 v[172:173], v[172:173], v[164:165]
    v_pk_mul_f32 v[174:175], v[174:175], v[166:167]
    v_cvt_pk_bf16_f32 v8, v168, v169
    v_cvt_pk_bf16_f32 v9, v170, v171
    v_cvt_pk_bf16_f32 v10, v172, v173
    v_cvt_pk_bf16_f32 v11, v174, v175
    s_add_u32 s65, s62, 229376
    buffer_store_dwordx4 v[8:11], v102, s[20:23], s65 offen sc1
    v_pk_fma_f32 v[176:177], v[48:49], v[38:39], v[176:177] op_sel_hi:[1,0,1] neg_lo:[0,1,0] neg_hi:[0,1,0]
    v_pk_fma_f32 v[178:179], v[50:51], v[38:39], v[178:179] op_sel_hi:[1,0,1] neg_lo:[0,1,0] neg_hi:[0,1,0]
    v_pk_fma_f32 v[180:181], v[52:53], v[38:39], v[180:181] op_sel_hi:[1,0,1] neg_lo:[0,1,0] neg_hi:[0,1,0]
    v_pk_fma_f32 v[182:183], v[54:55], v[38:39], v[182:183] op_sel_hi:[1,0,1] neg_lo:[0,1,0] neg_hi:[0,1,0]
    v_pk_mul_f32 v[176:177], v[176:177], v[38:39] op_sel:[0,1] op_sel_hi:[1,1]
    v_pk_mul_f32 v[178:179], v[178:179], v[38:39] op_sel:[0,1] op_sel_hi:[1,1]
    v_pk_mul_f32 v[180:181], v[180:181], v[38:39] op_sel:[0,1] op_sel_hi:[1,1]
    v_pk_mul_f32 v[182:183], v[182:183], v[38:39] op_sel:[0,1] op_sel_hi:[1,1]
    v_exp_f32 v176, v176
    v_exp_f32 v177, v177
    v_exp_f32 v178, v178
    v_exp_f32 v179, v179
    v_exp_f32 v180, v180
    v_exp_f32 v181, v181
    v_exp_f32 v182, v182
    v_exp_f32 v183, v183
    v_pk_add_f32 v[176:177], v[176:177], s[66:67]
    v_pk_add_f32 v[178:179], v[178:179], s[66:67]
    v_pk_add_f32 v[180:181], v[180:181], s[66:67]
    v_pk_add_f32 v[182:183], v[182:183], s[66:67]
    v_rcp_f32 v176, v176
    v_rcp_f32 v177, v177
    v_rcp_f32 v178, v178
    v_rcp_f32 v179, v179
    v_rcp_f32 v180, v180
    v_rcp_f32 v181, v181
    v_rcp_f32 v182, v182
    v_rcp_f32 v183, v183
    v_pk_fma_f32 v[184:185], v[56:57], v[38:39], v[184:185] op_sel_hi:[1,0,1] neg_lo:[0,1,0] neg_hi:[0,1,0]
    v_pk_fma_f32 v[186:187], v[58:59], v[38:39], v[186:187] op_sel_hi:[1,0,1] neg_lo:[0,1,0] neg_hi:[0,1,0]
    v_pk_fma_f32 v[188:189], v[60:61], v[38:39], v[188:189] op_sel_hi:[1,0,1] neg_lo:[0,1,0] neg_hi:[0,1,0]
    v_pk_fma_f32 v[190:191], v[62:63], v[38:39], v[190:191] op_sel_hi:[1,0,1] neg_lo:[0,1,0] neg_hi:[0,1,0]
    v_pk_mul_f32 v[184:185], v[184:185], v[176:177]
    v_pk_mul_f32 v[186:187], v[186:187], v[178:179]
    v_pk_mul_f32 v[188:189], v[188:189], v[180:181]
    v_pk_mul_f32 v[190:191], v[190:191], v[182:183]
    v_cvt_pk_bf16_f32 v12, v184, v185
    v_cvt_pk_bf16_f32 v13, v186, v187
    v_cvt_pk_bf16_f32 v14, v188, v189
    v_cvt_pk_bf16_f32 v15, v190, v191
    s_add_u32 s65, s62, 229632
    buffer_store_dwordx4 v[12:15], v102, s[20:23], s65 offen sc1
    v_pk_fma_f32 v[192:193], v[48:49], v[40:41], v[192:193] op_sel_hi:[1,0,1] neg_lo:[0,1,0] neg_hi:[0,1,0]
    v_pk_fma_f32 v[194:195], v[50:51], v[40:41], v[194:195] op_sel_hi:[1,0,1] neg_lo:[0,1,0] neg_hi:[0,1,0]
    v_pk_fma_f32 v[196:197], v[52:53], v[40:41], v[196:197] op_sel_hi:[1,0,1] neg_lo:[0,1,0] neg_hi:[0,1,0]
    v_pk_fma_f32 v[198:199], v[54:55], v[40:41], v[198:199] op_sel_hi:[1,0,1] neg_lo:[0,1,0] neg_hi:[0,1,0]
    v_pk_mul_f32 v[192:193], v[192:193], v[40:41] op_sel:[0,1] op_sel_hi:[1,1]
    v_pk_mul_f32 v[194:195], v[194:195], v[40:41] op_sel:[0,1] op_sel_hi:[1,1]
    v_pk_mul_f32 v[196:197], v[196:197], v[40:41] op_sel:[0,1] op_sel_hi:[1,1]
    v_pk_mul_f32 v[198:199], v[198:199], v[40:41] op_sel:[0,1] op_sel_hi:[1,1]
    v_exp_f32 v192, v192
    v_exp_f32 v193, v193
    v_exp_f32 v194, v194
    v_exp_f32 v195, v195
    v_exp_f32 v196, v196
    v_exp_f32 v197, v197
    v_exp_f32 v198, v198
    v_exp_f32 v199, v199
    v_pk_add_f32 v[192:193], v[192:193], s[66:67]
    v_pk_add_f32 v[194:195], v[194:195], s[66:67]
    v_pk_add_f32 v[196:197], v[196:197], s[66:67]
    v_pk_add_f32 v[198:199], v[198:199], s[66:67]
    v_rcp_f32 v192, v192
    v_rcp_f32 v193, v193
    v_rcp_f32 v194, v194
    v_rcp_f32 v195, v195
    v_rcp_f32 v196, v196
    v_rcp_f32 v197, v197
    v_rcp_f32 v198, v198
    v_rcp_f32 v199, v199
    v_pk_fma_f32 v[200:201], v[56:57], v[40:41], v[200:201] op_sel_hi:[1,0,1] neg_lo:[0,1,0] neg_hi:[0,1,0]
    v_pk_fma_f32 v[202:203], v[58:59], v[40:41], v[202:203] op_sel_hi:[1,0,1] neg_lo:[0,1,0] neg_hi:[0,1,0]
    v_pk_fma_f32 v[204:205], v[60:61], v[40:41], v[204:205] op_sel_hi:[1,0,1] neg_lo:[0,1,0] neg_hi:[0,1,0]
    v_pk_fma_f32 v[206:207], v[62:63], v[40:41], v[206:207] op_sel_hi:[1,0,1] neg_lo:[0,1,0] neg_hi:[0,1,0]
    v_pk_mul_f32 v[200:201], v[200:201], v[192:193]
    v_pk_mul_f32 v[202:203], v[202:203], v[194:195]
    v_pk_mul_f32 v[204:205], v[204:205], v[196:197]
    v_pk_mul_f32 v[206:207], v[206:207], v[198:199]
    v_cvt_pk_bf16_f32 v16, v200, v201
    v_cvt_pk_bf16_f32 v17, v202, v203
    v_cvt_pk_bf16_f32 v18, v204, v205
    v_cvt_pk_bf16_f32 v19, v206, v207
    s_add_u32 s65, s62, 114688
    buffer_store_dwordx4 v[16:19], v102, s[20:23], s65 offen sc1
    v_pk_fma_f32 v[208:209], v[48:49], v[42:43], v[208:209] op_sel_hi:[1,0,1] neg_lo:[0,1,0] neg_hi:[0,1,0]
    v_pk_fma_f32 v[210:211], v[50:51], v[42:43], v[210:211] op_sel_hi:[1,0,1] neg_lo:[0,1,0] neg_hi:[0,1,0]
    v_pk_fma_f32 v[212:213], v[52:53], v[42:43], v[212:213] op_sel_hi:[1,0,1] neg_lo:[0,1,0] neg_hi:[0,1,0]
    v_pk_fma_f32 v[214:215], v[54:55], v[42:43], v[214:215] op_sel_hi:[1,0,1] neg_lo:[0,1,0] neg_hi:[0,1,0]
    v_pk_mul_f32 v[208:209], v[208:209], v[42:43] op_sel:[0,1] op_sel_hi:[1,1]
    v_pk_mul_f32 v[210:211], v[210:211], v[42:43] op_sel:[0,1] op_sel_hi:[1,1]
    v_pk_mul_f32 v[212:213], v[212:213], v[42:43] op_sel:[0,1] op_sel_hi:[1,1]
    v_pk_mul_f32 v[214:215], v[214:215], v[42:43] op_sel:[0,1] op_sel_hi:[1,1]
    v_exp_f32 v208, v208
    v_exp_f32 v209, v209
    v_exp_f32 v210, v210
    v_exp_f32 v211, v211
    v_exp_f32 v212, v212
    v_exp_f32 v213, v213
    v_exp_f32 v214, v214
    v_exp_f32 v215, v215
    v_pk_add_f32 v[208:209], v[208:209], s[66:67]
    v_pk_add_f32 v[210:211], v[210:211], s[66:67]
    v_pk_add_f32 v[212:213], v[212:213], s[66:67]
    v_pk_add_f32 v[214:215], v[214:215], s[66:67]
    v_rcp_f32 v208, v208
    v_rcp_f32 v209, v209
    v_rcp_f32 v210, v210
    v_rcp_f32 v211, v211
    v_rcp_f32 v212, v212
    v_rcp_f32 v213, v213
    v_rcp_f32 v214, v214
    v_rcp_f32 v215, v215
    v_pk_fma_f32 v[216:217], v[56:57], v[42:43], v[216:217] op_sel_hi:[1,0,1] neg_lo:[0,1,0] neg_hi:[0,1,0]
    v_pk_fma_f32 v[218:219], v[58:59], v[42:43], v[218:219] op_sel_hi:[1,0,1] neg_lo:[0,1,0] neg_hi:[0,1,0]
    v_pk_fma_f32 v[220:221], v[60:61], v[42:43], v[220:221] op_sel_hi:[1,0,1] neg_lo:[0,1,0] neg_hi:[0,1,0]
    v_pk_fma_f32 v[222:223], v[62:63], v[42:43], v[222:223] op_sel_hi:[1,0,1] neg_lo:[0,1,0] neg_hi:[0,1,0]
    v_pk_mul_f32 v[216:217], v[216:217], v[208:209]
    v_pk_mul_f32 v[218:219], v[218:219], v[210:211]
    v_pk_mul_f32 v[220:221], v[220:221], v[212:213]
    v_pk_mul_f32 v[222:223], v[222:223], v[214:215]
    v_cvt_pk_bf16_f32 v20, v216, v217
    v_cvt_pk_bf16_f32 v21, v218, v219
    v_cvt_pk_bf16_f32 v22, v220, v221
    v_cvt_pk_bf16_f32 v23, v222, v223
    s_add_u32 s65, s62, 114944
    buffer_store_dwordx4 v[20:23], v102, s[20:23], s65 offen sc1
    v_pk_fma_f32 v[224:225], v[48:49], v[44:45], v[224:225] op_sel_hi:[1,0,1] neg_lo:[0,1,0] neg_hi:[0,1,0]
    v_pk_fma_f32 v[226:227], v[50:51], v[44:45], v[226:227] op_sel_hi:[1,0,1] neg_lo:[0,1,0] neg_hi:[0,1,0]
    v_pk_fma_f32 v[228:229], v[52:53], v[44:45], v[228:229] op_sel_hi:[1,0,1] neg_lo:[0,1,0] neg_hi:[0,1,0]
    v_pk_fma_f32 v[230:231], v[54:55], v[44:45], v[230:231] op_sel_hi:[1,0,1] neg_lo:[0,1,0] neg_hi:[0,1,0]
    v_pk_mul_f32 v[224:225], v[224:225], v[44:45] op_sel:[0,1] op_sel_hi:[1,1]
    v_pk_mul_f32 v[226:227], v[226:227], v[44:45] op_sel:[0,1] op_sel_hi:[1,1]
    v_pk_mul_f32 v[228:229], v[228:229], v[44:45] op_sel:[0,1] op_sel_hi:[1,1]
    v_pk_mul_f32 v[230:231], v[230:231], v[44:45] op_sel:[0,1] op_sel_hi:[1,1]
    v_exp_f32 v224, v224
    v_exp_f32 v225, v225
    v_exp_f32 v226, v226
    v_exp_f32 v227, v227
    v_exp_f32 v228, v228
    v_exp_f32 v229, v229
    v_exp_f32 v230, v230
    v_exp_f32 v231, v231
    v_pk_add_f32 v[224:225], v[224:225], s[66:67]
    v_pk_add_f32 v[226:227], v[226:227], s[66:67]
    v_pk_add_f32 v[228:229], v[228:229], s[66:67]
    v_pk_add_f32 v[230:231], v[230:231], s[66:67]
    v_rcp_f32 v224, v224
    v_rcp_f32 v225, v225
    v_rcp_f32 v226, v226
    v_rcp_f32 v227, v227
    v_rcp_f32 v228, v228
    v_rcp_f32 v229, v229
    v_rcp_f32 v230, v230
    v_rcp_f32 v231, v231
    v_pk_fma_f32 v[232:233], v[56:57], v[44:45], v[232:233] op_sel_hi:[1,0,1] neg_lo:[0,1,0] neg_hi:[0,1,0]
    v_pk_fma_f32 v[234:235], v[58:59], v[44:45], v[234:235] op_sel_hi:[1,0,1] neg_lo:[0,1,0] neg_hi:[0,1,0]
    v_pk_fma_f32 v[236:237], v[60:61], v[44:45], v[236:237] op_sel_hi:[1,0,1] neg_lo:[0,1,0] neg_hi:[0,1,0]
    v_pk_fma_f32 v[238:239], v[62:63], v[44:45], v[238:239] op_sel_hi:[1,0,1] neg_lo:[0,1,0] neg_hi:[0,1,0]
    v_pk_mul_f32 v[232:233], v[232:233], v[224:225]
    v_pk_mul_f32 v[234:235], v[234:235], v[226:227]
    v_pk_mul_f32 v[236:237], v[236:237], v[228:229]
    v_pk_mul_f32 v[238:239], v[238:239], v[230:231]
    v_cvt_pk_bf16_f32 v24, v232, v233
    v_cvt_pk_bf16_f32 v25, v234, v235
    v_cvt_pk_bf16_f32 v26, v236, v237
    v_cvt_pk_bf16_f32 v27, v238, v239
    s_add_u32 s65, s62, 344064
    buffer_store_dwordx4 v[24:27], v102, s[20:23], s65 offen sc1
    v_pk_fma_f32 v[240:241], v[48:49], v[46:47], v[240:241] op_sel_hi:[1,0,1] neg_lo:[0,1,0] neg_hi:[0,1,0]
    v_pk_fma_f32 v[242:243], v[50:51], v[46:47], v[242:243] op_sel_hi:[1,0,1] neg_lo:[0,1,0] neg_hi:[0,1,0]
    v_pk_fma_f32 v[244:245], v[52:53], v[46:47], v[244:245] op_sel_hi:[1,0,1] neg_lo:[0,1,0] neg_hi:[0,1,0]
    v_pk_fma_f32 v[246:247], v[54:55], v[46:47], v[246:247] op_sel_hi:[1,0,1] neg_lo:[0,1,0] neg_hi:[0,1,0]
    v_pk_mul_f32 v[240:241], v[240:241], v[46:47] op_sel:[0,1] op_sel_hi:[1,1]
    v_pk_mul_f32 v[242:243], v[242:243], v[46:47] op_sel:[0,1] op_sel_hi:[1,1]
    v_pk_mul_f32 v[244:245], v[244:245], v[46:47] op_sel:[0,1] op_sel_hi:[1,1]
    v_pk_mul_f32 v[246:247], v[246:247], v[46:47] op_sel:[0,1] op_sel_hi:[1,1]
    v_exp_f32 v240, v240
    v_exp_f32 v241, v241
    v_exp_f32 v242, v242
    v_exp_f32 v243, v243
    v_exp_f32 v244, v244
    v_exp_f32 v245, v245
    v_exp_f32 v246, v246
    v_exp_f32 v247, v247
    v_pk_add_f32 v[240:241], v[240:241], s[66:67]
    v_pk_add_f32 v[242:243], v[242:243], s[66:67]
    v_pk_add_f32 v[244:245], v[244:245], s[66:67]
    v_pk_add_f32 v[246:247], v[246:247], s[66:67]
    v_rcp_f32 v240, v240
    v_rcp_f32 v241, v241
    v_rcp_f32 v242, v242
    v_rcp_f32 v243, v243
    v_rcp_f32 v244, v244
    v_rcp_f32 v245, v245
    v_rcp_f32 v246, v246
    v_rcp_f32 v247, v247
    v_pk_fma_f32 v[248:249], v[56:57], v[46:47], v[248:249] op_sel_hi:[1,0,1] neg_lo:[0,1,0] neg_hi:[0,1,0]
    v_pk_fma_f32 v[250:251], v[58:59], v[46:47], v[250:251] op_sel_hi:[1,0,1] neg_lo:[0,1,0] neg_hi:[0,1,0]
    v_pk_fma_f32 v[252:253], v[60:61], v[46:47], v[252:253] op_sel_hi:[1,0,1] neg_lo:[0,1,0] neg_hi:[0,1,0]
    v_pk_fma_f32 v[254:255], v[62:63], v[46:47], v[254:255] op_sel_hi:[1,0,1] neg_lo:[0,1,0] neg_hi:[0,1,0]
    v_pk_mul_f32 v[248:249], v[248:249], v[240:241]
    v_pk_mul_f32 v[250:251], v[250:251], v[242:243]
    v_pk_mul_f32 v[252:253], v[252:253], v[244:245]
    v_pk_mul_f32 v[254:255], v[254:255], v[246:247]
    v_cvt_pk_bf16_f32 v28, v248, v249
    v_cvt_pk_bf16_f32 v29, v250, v251
    v_cvt_pk_bf16_f32 v30, v252, v253
    v_cvt_pk_bf16_f32 v31, v254, v255
    s_add_u32 s65, s62, 344320
    buffer_store_dwordx4 v[28:31], v102, s[20:23], s65 offen sc1
    v_mov_b32 v43, v96
    v_mov_b32 v41, 1
    v_mov_b32 v42, 0
    s_mov_b64 exec, 1
    s_waitcnt vmcnt(0)
    ds_add_rtn_u32 v41, v116, v41 offset:4
    s_waitcnt lgkmcnt(0)
    v_readfirstlane_b32 s64, v41
    s_cmp_lg_u32 s64, 3
    s_cbranch_scc1 HNOFLAG
    buffer_store_dword v43, v42, s[20:23], s61 offen sc1
HNOFLAG:
    s_mov_b64 exec, -1
PHASE2:
    v_and_b32 v89, 31, v117
    v_lshrrev_b32 v90, 5, v117
    v_bfe_u32 v248, v117, 2, 2
    v_lshl_add_u32 v92, v90, 2, v248
    s_lshl_b32 s68, s74, 10
    v_lshl_add_u32 v92, v92, 7, s68
    v_and_b32 v93, 1, v117
    v_lshlrev_b32 v93, 2, v93
    v_bfe_u32 v249, v117, 4, 1
    v_lshl_add_u32 v93, v249, 1, v93
    v_bfe_u32 v249, v117, 1, 1
    v_add_u32 v93, v93, v249
    v_lshl_add_u32 v92, v93, 3, v92
    v_lshrrev_b32 v248, 1, v248
    v_xor_b32 v248, s74, v248
    v_lshl_add_u32 v112, v248, 6, v92
    v_xor_b32 v113, 64, v112
    v_lshlrev_b32 v114, 4, v117
    s_cmp_ge_u32 s40, 4
    s_cselect_b64 s[70:71], -1, 0
    s_lshl_b32 s68, s74, 9
    s_add_u32 s68, s68, 98304
    v_lshl_add_u32 v116, v89, 4, s68
    v_lshl_add_u32 v116, v90, 10, v116
    s_lshl_b32 s68, s73, 7
    s_add_u32 s68, s68, 150784
    v_lshl_add_u32 v93, v89, 2, s68
    ds_read_b32 v88, v93
    v_lshl_add_u32 v91, v89, 1, s73
    v_sub_u32 v92, s63, v91
    v_cndmask_b32 v91, v91, v92, s[70:71]
    v_and_b32 v124, 1, v91
    v_mul_u32_u24 v124, 0x8000, v124
    v_lshl_or_b32 v124, v124, 16, v124
    v_cvt_f32_u32 v91, v91
    v_mul_f32 v122, 0x3c800000, v91
    v_lshlrev_b32 v92, 1, v90
    v_cvt_f32_u32 v92, v92
    v_mul_f32 v123, v122, v92
    v_fmamk_f32 v248, v122, 0x0, v123
    v_fmamk_f32 v249, v122, 0x3f800000, v123
    v_fract_f32 v248, v248
    v_fract_f32 v249, v249
    v_cos_f32 v250, v248
    v_sin_f32 v252, v248
    v_cos_f32 v251, v249
    v_sin_f32 v253, v249
    v_cvt_pk_bf16_f32 v32, v250, v252
    v_cvt_pk_bf16_f32 v33, v251, v253
    v_xor_b32 v34, v124, v32
    v_xor_b32 v35, v124, v33
    v_fmamk_f32 v248, v122, 0x40800000, v123
    v_fmamk_f32 v249, v122, 0x40a00000, v123
    v_fract_f32 v248, v248
    v_fract_f32 v249, v249
    v_cos_f32 v250, v248
    v_sin_f32 v252, v248
    v_cos_f32 v251, v249
    v_sin_f32 v253, v249
    v_cvt_pk_bf16_f32 v36, v250, v252
    v_cvt_pk_bf16_f32 v37, v251, v253
    v_xor_b32 v38, v124, v36
    v_xor_b32 v39, v124, v37
    v_fmamk_f32 v248, v122, 0x41000000, v123
    v_fmamk_f32 v249, v122, 0x41100000, v123
    v_fract_f32 v248, v248
    v_fract_f32 v249, v249
    v_cos_f32 v250, v248
    v_sin_f32 v252, v248
    v_cos_f32 v251, v249
    v_sin_f32 v253, v249
    v_cvt_pk_bf16_f32 v40, v250, v252
    v_cvt_pk_bf16_f32 v41, v251, v253
    v_xor_b32 v42, v124, v40
    v_xor_b32 v43, v124, v41
    v_fmamk_f32 v248, v122, 0x41400000, v123
    v_fmamk_f32 v249, v122, 0x41500000, v123
    v_fract_f32 v248, v248
    v_fract_f32 v249, v249
    v_cos_f32 v250, v248
    v_sin_f32 v252, v248
    v_cos_f32 v251, v249
    v_sin_f32 v253, v249
    v_cvt_pk_bf16_f32 v44, v250, v252
    v_cvt_pk_bf16_f32 v45, v251, v253
    v_xor_b32 v46, v124, v44
    v_xor_b32 v47, v124, v45
    v_fmamk_f32 v248, v122, 0x41800000, v123
    v_fmamk_f32 v249, v122, 0x41880000, v123
    v_fract_f32 v248, v248
    v_fract_f32 v249, v249
    v_cos_f32 v250, v248
    v_sin_f32 v252, v248
    v_cos_f32 v251, v249
    v_sin_f32 v253, v249
    v_cvt_pk_bf16_f32 v48, v250, v252
    v_cvt_pk_bf16_f32 v49, v251, v253
    v_xor_b32 v50, v124, v48
    v_xor_b32 v51, v124, v49
    v_fmamk_f32 v248, v122, 0x41a00000, v123
    v_fmamk_f32 v249, v122, 0x41a80000, v123
    v_fract_f32 v248, v248
    v_fract_f32 v249, v249
    v_cos_f32 v250, v248
    v_sin_f32 v252, v248
    v_cos_f32 v251, v249
    v_sin_f32 v253, v249
    v_cvt_pk_bf16_f32 v52, v250, v252
    v_cvt_pk_bf16_f32 v53, v251, v253
    v_xor_b32 v54, v124, v52
    v_xor_b32 v55, v124, v53
    v_fmamk_f32 v248, v122, 0x41c00000, v123
    v_fmamk_f32 v249, v122, 0x41c80000, v123
    v_fract_f32 v248, v248
    v_fract_f32 v249, v249
    v_cos_f32 v250, v248
    v_sin_f32 v252, v248
    v_cos_f32 v251, v249
    v_sin_f32 v253, v249
    v_cvt_pk_bf16_f32 v56, v250, v252
    v_cvt_pk_bf16_f32 v57, v251, v253
    v_xor_b32 v58, v124, v56
    v_xor_b32 v59, v124, v57
    v_fmamk_f32 v248, v122, 0x41e00000, v123
    v_fmamk_f32 v249, v122, 0x41e80000, v123
    v_fract_f32 v248, v248
    v_fract_f32 v249, v249
    v_cos_f32 v250, v248
    v_sin_f32 v252, v248
    v_cos_f32 v251, v249
    v_sin_f32 v253, v249
    v_cvt_pk_bf16_f32 v60, v250, v252
    v_cvt_pk_bf16_f32 v61, v251, v253
    v_xor_b32 v62, v124, v60
    v_xor_b32 v63, v124, v61
    s_lshl_b32 s68, s36, 12
    s_add_u32 s68, s68, 81920
    v_lshl_add_u32 v91, v117, 4, s68
    v_xor_b32 v92, 8192, v91
    v_mov_b32 v93, 0xffff0000
    s_cmp_eq_u32 s43, 0
    s_cbranch_scc1 NOZP
    v_mov_b32 v94, 150532
    v_mov_b32 v95, 1
    v_mov_b32 v126, s44
    v_mov_b32 v127, 0
    s_mov_b64 exec, 1
    s_waitcnt vmcnt(0)
    ds_add_rtn_u32 v95, v94, v95 offset:4
    s_waitcnt lgkmcnt(0)
    v_readfirstlane_b32 s64, v95
    s_cmp_lg_u32 s64, 3
    s_cbranch_scc1 NOZF
    buffer_store_dword v126, v127, s[20:23], s61 offen sc1
NOZF:
    s_mov_b64 exec, -1
NOZP:
    s_waitcnt lgkmcnt(0)
    v_lshlrev_b32 v64, 16, v80
    v_and_b32 v65, v93, v80
    v_lshlrev_b32 v66, 16, v81
    v_and_b32 v67, v93, v81
    v_lshlrev_b32 v68, 16, v82
    v_and_b32 v69, v93, v82
    v_lshlrev_b32 v70, 16, v83
    v_and_b32 v71, v93, v83
    v_lshlrev_b32 v72, 16, v84
    v_and_b32 v73, v93, v84
    v_lshlrev_b32 v74, 16, v85
    v_and_b32 v75, v93, v85
    v_lshlrev_b32 v76, 16, v86
    v_and_b32 v77, v93, v86
    v_lshlrev_b32 v78, 16, v87
    v_and_b32 v79, v93, v87
    v_mul_f32 v89, 0xbfb8aa3b, v88
    s_barrier
    buffer_load_dwordx4 v[176:179], v114, s[20:23], s57 offen offset:0 sc1
    buffer_load_dwordx4 v[180:183], v114, s[20:23], s57 offen offset:1024 sc1
    ds_read_b64_tr_b16 v[96:97], v112 offset:0
    ds_read_b64_tr_b16 v[98:99], v112 offset:2048
    ds_read_b64_tr_b16 v[100:101], v113 offset:0
    ds_read_b64_tr_b16 v[102:103], v113 offset:2048
    ds_read_b64_tr_b16 v[104:105], v112 offset:4096
    ds_read_b64_tr_b16 v[106:107], v112 offset:6144
    ds_read_b64_tr_b16 v[108:109], v113 offset:4096
    ds_read_b64_tr_b16 v[110:111], v113 offset:6144
    buffer_load_dwordx4 v[184:187], v114, s[20:23], s57 offen offset:2048 sc1
    buffer_load_dwordx4 v[188:191], v114, s[20:23], s57 offen offset:3072 sc1
    s_add_u32 s57, s57, 4096
    buffer_load_dwordx4 v[192:195], v114, s[20:23], s57 offen offset:0 sc1
    buffer_load_dwordx4 v[196:199], v114, s[20:23], s57 offen offset:1024 sc1
    s_waitcnt vmcnt(5) lgkmcnt(4)
    v_mfma_f32_32x32x16_bf16 v[128:143], v[96:99], v[176:179], 0
    ds_read_b64_tr_b16 v[240:241], v112 offset:8192
    ds_read_b64_tr_b16 v[242:243], v112 offset:10240
    ds_read_b64_tr_b16 v[244:245], v113 offset:8192
    ds_read_b64_tr_b16 v[246:247], v113 offset:10240
    v_mfma_f32_32x32x16_bf16 v[144:159], v[100:103], v[176:179], 0
    buffer_load_dwordx4 v[200:203], v114, s[20:23], s57 offen offset:2048 sc1
    buffer_load_dwordx4 v[204:207], v114, s[20:23], s57 offen offset:3072 sc1
    s_add_u32 s57, s57, 4096
    s_waitcnt vmcnt(6) lgkmcnt(4)
    v_mfma_f32_32x32x16_bf16 v[128:143], v[104:107], v[180:183], v[128:143]
    ds_read_b64_tr_b16 v[96:97], v112 offset:12288
    ds_read_b64_tr_b16 v[98:99], v112 offset:14336
    ds_read_b64_tr_b16 v[100:101], v113 offset:12288
    ds_read_b64_tr_b16 v[102:103], v113 offset:14336
    v_mfma_f32_32x32x16_bf16 v[144:159], v[108:111], v[180:183], v[144:159]
    buffer_load_dwordx4 v[208:211], v114, s[20:23], s57 offen offset:0 sc1
    buffer_load_dwordx4 v[212:215], v114, s[20:23], s57 offen offset:1024 sc1
    s_waitcnt vmcnt(7) lgkmcnt(4)
    v_mfma_f32_32x32x16_bf16 v[128:143], v[240:243], v[184:187], v[128:143]
    ds_read_b64_tr_b16 v[104:105], v112 offset:16384
    ds_read_b64_tr_b16 v[106:107], v112 offset:18432
    ds_read_b64_tr_b16 v[108:109], v113 offset:16384
    ds_read_b64_tr_b16 v[110:111], v113 offset:18432
    v_mfma_f32_32x32x16_bf16 v[144:159], v[244:247], v[184:187], v[144:159]
    buffer_load_dwordx4 v[216:219], v114, s[20:23], s57 offen offset:2048 sc1
    buffer_load_dwordx4 v[220:223], v114, s[20:23], s57 offen offset:3072 sc1
    s_add_u32 s57, s57, 4096
    s_waitcnt vmcnt(8) lgkmcnt(4)
    v_mfma_f32_32x32x16_bf16 v[128:143], v[96:99], v[188:191], v[128:143]
    ds_read_b64_tr_b16 v[240:241], v112 offset:20480
    ds_read_b64_tr_b16 v[242:243], v112 offset:22528
    ds_read_b64_tr_b16 v[244:245], v113 offset:20480
    ds_read_b64_tr_b16 v[246:247], v113 offset:22528
    v_mfma_f32_32x32x16_bf16 v[144:159], v[100:103], v[188:191], v[144:159]
    buffer_load_dwordx4 v[176:179], v114, s[20:23], s57 offen offset:0 sc1
    buffer_load_dwordx4 v[180:183], v114, s[20:23], s57 offen offset:1024 sc1
    s_waitcnt vmcnt(9) lgkmcnt(4)
    v_mfma_f32_32x32x16_bf16 v[128:143], v[104:107], v[192:195], v[128:143]
    ds_read_b64_tr_b16 v[96:97], v112 offset:24576
    ds_read_b64_tr_b16 v[98:99], v112 offset:26624
    ds_read_b64_tr_b16 v[100:101], v113 offset:24576
    ds_read_b64_tr_b16 v[102:103], v113 offset:26624
    v_mfma_f32_32x32x16_bf16 v[144:159], v[108:111], v[192:195], v[144:159]
    buffer_load_dwordx4 v[184:187], v114, s[20:23], s57 offen offset:2048 sc1
    buffer_load_dwordx4 v[188:191], v114, s[20:23], s57 offen offset:3072 sc1
    s_add_u32 s57, s57, 4096
    s_waitcnt vmcnt(10) lgkmcnt(4)
    v_mfma_f32_32x32x16_bf16 v[128:143], v[240:243], v[196:199], v[128:143]
    ds_read_b64_tr_b16 v[104:105], v112 offset:28672
    ds_read_b64_tr_b16 v[106:107], v112 offset:30720
    ds_read_b64_tr_b16 v[108:109], v113 offset:28672
    ds_read_b64_tr_b16 v[110:111], v113 offset:30720
    v_mfma_f32_32x32x16_bf16 v[144:159], v[244:247], v[196:199], v[144:159]
    buffer_load_dwordx4 v[192:195], v114, s[20:23], s57 offen offset:0 sc1
    buffer_load_dwordx4 v[196:199], v114, s[20:23], s57 offen offset:1024 sc1
    s_waitcnt vmcnt(11) lgkmcnt(4)
    v_mfma_f32_32x32x16_bf16 v[128:143], v[96:99], v[200:203], v[128:143]
    ds_read_b64_tr_b16 v[240:241], v112 offset:32768
    ds_read_b64_tr_b16 v[242:243], v112 offset:34816
    ds_read_b64_tr_b16 v[244:245], v113 offset:32768
    ds_read_b64_tr_b16 v[246:247], v113 offset:34816
    v_mfma_f32_32x32x16_bf16 v[144:159], v[100:103], v[200:203], v[144:159]
    buffer_load_dwordx4 v[200:203], v114, s[20:23], s57 offen offset:2048 sc1
    s_waitcnt vmcnt(11) lgkmcnt(4)
    v_mfma_f32_32x32x16_bf16 v[128:143], v[104:107], v[204:207], v[128:143]
    ds_read_b64_tr_b16 v[96:97], v112 offset:36864
    ds_read_b64_tr_b16 v[98:99], v112 offset:38912
    ds_read_b64_tr_b16 v[100:101], v113 offset:36864
    ds_read_b64_tr_b16 v[102:103], v113 offset:38912
    v_mfma_f32_32x32x16_bf16 v[144:159], v[108:111], v[204:207], v[144:159]
    buffer_load_dwordx4 v[204:207], v114, s[20:23], s57 offen offset:3072 sc1
    s_add_u32 s57, s57, 4096
    s_waitcnt vmcnt(11) lgkmcnt(4)
    v_mfma_f32_32x32x16_bf16 v[128:143], v[240:243], v[208:211], v[128:143]
    ds_read_b64_tr_b16 v[104:105], v112 offset:40960
    ds_read_b64_tr_b16 v[106:107], v112 offset:43008
    ds_read_b64_tr_b16 v[108:109], v113 offset:40960
    ds_read_b64_tr_b16 v[110:111], v113 offset:43008
    v_mfma_f32_32x32x16_bf16 v[144:159], v[244:247], v[208:211], v[144:159]
    buffer_load_dwordx4 v[208:211], v114, s[20:23], s57 offen offset:0 sc1
    s_waitcnt vmcnt(11) lgkmcnt(4)
    v_mfma_f32_32x32x16_bf16 v[128:143], v[96:99], v[212:215], v[128:143]
    ds_read_b64_tr_b16 v[240:241], v112 offset:45056
    ds_read_b64_tr_b16 v[242:243], v112 offset:47104
    ds_read_b64_tr_b16 v[244:245], v113 offset:45056
    ds_read_b64_tr_b16 v[246:247], v113 offset:47104
    v_mfma_f32_32x32x16_bf16 v[144:159], v[100:103], v[212:215], v[144:159]
    buffer_load_dwordx4 v[212:215], v114, s[20:23], s57 offen offset:1024 sc1
    s_waitcnt vmcnt(11) lgkmcnt(4)
    v_mfma_f32_32x32x16_bf16 v[128:143], v[104:107], v[216:219], v[128:143]
    ds_read_b64_tr_b16 v[96:97], v112 offset:49152
    ds_read_b64_tr_b16 v[98:99], v112 offset:51200
    ds_read_b64_tr_b16 v[100:101], v113 offset:49152
    ds_read_b64_tr_b16 v[102:103], v113 offset:51200
    v_mfma_f32_32x32x16_bf16 v[144:159], v[108:111], v[216:219], v[144:159]
    buffer_load_dwordx4 v[216:219], v114, s[20:23], s57 offen offset:2048 sc1
    s_waitcnt vmcnt(11) lgkmcnt(4)
    v_mfma_f32_32x32x16_bf16 v[128:143], v[240:243], v[220:223], v[128:143]
    ds_read_b64_tr_b16 v[104:105], v112 offset:53248
    ds_read_b64_tr_b16 v[106:107], v112 offset:55296
    ds_read_b64_tr_b16 v[108:109], v113 offset:53248
    ds_read_b64_tr_b16 v[110:111], v113 offset:55296
    v_mfma_f32_32x32x16_bf16 v[144:159], v[244:247], v[220:223], v[144:159]
    buffer_load_dwordx4 v[220:223], v114, s[20:23], s57 offen offset:3072 sc1
    s_add_u32 s57, s57, 4096
    s_waitcnt vmcnt(11) lgkmcnt(4)
    v_mfma_f32_32x32x16_bf16 v[128:143], v[96:99], v[176:179], v[128:143]
    ds_read_b64_tr_b16 v[240:241], v112 offset:57344
    ds_read_b64_tr_b16 v[242:243], v112 offset:59392
    ds_read_b64_tr_b16 v[244:245], v113 offset:57344
    ds_read_b64_tr_b16 v[246:247], v113 offset:59392
    v_mfma_f32_32x32x16_bf16 v[144:159], v[100:103], v[176:179], v[144:159]
    buffer_load_dwordx4 v[176:179], v114, s[20:23], s57 offen offset:0 sc1
    s_waitcnt vmcnt(11) lgkmcnt(4)
    v_mfma_f32_32x32x16_bf16 v[128:143], v[104:107], v[180:183], v[128:143]
    ds_read_b64_tr_b16 v[96:97], v112 offset:61440
    ds_read_b64_tr_b16 v[98:99], v112 offset:63488
    ds_read_b64_tr_b16 v[100:101], v113 offset:61440
    ds_read_b64_tr_b16 v[102:103], v113 offset:63488
    v_mfma_f32_32x32x16_bf16 v[144:159], v[108:111], v[180:183], v[144:159]
    buffer_load_dwordx4 v[180:183], v114, s[20:23], s57 offen offset:1024 sc1
    s_waitcnt vmcnt(11) lgkmcnt(4)
    v_mfma_f32_32x32x16_bf16 v[128:143], v[240:243], v[184:187], v[128:143]
    v_add_u32 v112, 0x10000, v112
    v_add_u32 v113, 0x10000, v113
    ds_read_b64_tr_b16 v[104:105], v112 offset:0
    ds_read_b64_tr_b16 v[106:107], v112 offset:2048
    ds_read_b64_tr_b16 v[108:109], v113 offset:0
    ds_read_b64_tr_b16 v[110:111], v113 offset:2048
    v_mfma_f32_32x32x16_bf16 v[144:159], v[244:247], v[184:187], v[144:159]
    buffer_load_dwordx4 v[184:187], v114, s[20:23], s57 offen offset:2048 sc1
    s_waitcnt vmcnt(11) lgkmcnt(4)
    v_mfma_f32_32x32x16_bf16 v[128:143], v[96:99], v[188:191], v[128:143]
    ds_read_b64_tr_b16 v[240:241], v112 offset:4096
    ds_read_b64_tr_b16 v[242:243], v112 offset:6144
    ds_read_b64_tr_b16 v[244:245], v113 offset:4096
    ds_read_b64_tr_b16 v[246:247], v113 offset:6144
    v_mfma_f32_32x32x16_bf16 v[144:159], v[100:103], v[188:191], v[144:159]
    buffer_load_dwordx4 v[188:191], v114, s[20:23], s57 offen offset:3072 sc1
    s_add_u32 s57, s57, 4096
    s_waitcnt vmcnt(11) lgkmcnt(4)
    v_mfma_f32_32x32x16_bf16 v[128:143], v[104:107], v[192:195], v[128:143]
    s_barrier
    ds_read_b64_tr_b16 v[96:97], v112 offset:8192
    ds_read_b64_tr_b16 v[98:99], v112 offset:10240
    ds_read_b64_tr_b16 v[100:101], v113 offset:8192
    ds_read_b64_tr_b16 v[102:103], v113 offset:10240
    v_mfma_f32_32x32x16_bf16 v[144:159], v[108:111], v[192:195], v[144:159]
    buffer_load_dwordx4 v[192:195], v114, s[20:23], s57 offen offset:0 sc1
    s_waitcnt vmcnt(11) lgkmcnt(4)
    v_mfma_f32_32x32x16_bf16 v[128:143], v[240:243], v[196:199], v[128:143]
    ds_read_b64_tr_b16 v[104:105], v112 offset:12288
    ds_read_b64_tr_b16 v[106:107], v112 offset:14336
    ds_read_b64_tr_b16 v[108:109], v113 offset:12288
    ds_read_b64_tr_b16 v[110:111], v113 offset:14336
    v_mfma_f32_32x32x16_bf16 v[144:159], v[244:247], v[196:199], v[144:159]
    buffer_load_dwordx4 v[196:199], v114, s[20:23], s57 offen offset:1024 sc1
    s_waitcnt vmcnt(11) lgkmcnt(4)
    v_mfma_f32_32x32x16_bf16 v[128:143], v[96:99], v[200:203], v[128:143]
    ds_read_b64_tr_b16 v[240:241], v112 offset:16384
    ds_read_b64_tr_b16 v[242:243], v112 offset:18432
    ds_read_b64_tr_b16 v[244:245], v113 offset:16384
    ds_read_b64_tr_b16 v[246:247], v113 offset:18432
    v_mfma_f32_32x32x16_bf16 v[144:159], v[100:103], v[200:203], v[144:159]
    buffer_load_dwordx4 v[200:203], v114, s[20:23], s57 offen offset:2048 sc1
    s_waitcnt vmcnt(11) lgkmcnt(4)
    v_mfma_f32_32x32x16_bf16 v[128:143], v[104:107], v[204:207], v[128:143]
    ds_read_b64_tr_b16 v[96:97], v112 offset:20480
    ds_read_b64_tr_b16 v[98:99], v112 offset:22528
    ds_read_b64_tr_b16 v[100:101], v113 offset:20480
    ds_read_b64_tr_b16 v[102:103], v113 offset:22528
    v_mfma_f32_32x32x16_bf16 v[144:159], v[108:111], v[204:207], v[144:159]
    buffer_load_dwordx4 v[204:207], v114, s[20:23], s57 offen offset:3072 sc1
    s_add_u32 s57, s57, 4096
    s_waitcnt vmcnt(11) lgkmcnt(4)
    v_mfma_f32_32x32x16_bf16 v[128:143], v[240:243], v[208:211], v[128:143]
    ds_read_b64_tr_b16 v[104:105], v112 offset:24576
    ds_read_b64_tr_b16 v[106:107], v112 offset:26624
    ds_read_b64_tr_b16 v[108:109], v113 offset:24576
    ds_read_b64_tr_b16 v[110:111], v113 offset:26624
    v_mfma_f32_32x32x16_bf16 v[144:159], v[244:247], v[208:211], v[144:159]
    buffer_load_dwordx4 v[208:211], v114, s[20:23], s57 offen offset:0 sc1
    s_waitcnt vmcnt(11) lgkmcnt(4)
    v_mfma_f32_32x32x16_bf16 v[128:143], v[96:99], v[212:215], v[128:143]
    ds_read_b64_tr_b16 v[240:241], v112 offset:28672
    ds_read_b64_tr_b16 v[242:243], v112 offset:30720
    ds_read_b64_tr_b16 v[244:245], v113 offset:28672
    ds_read_b64_tr_b16 v[246:247], v113 offset:30720
    v_mfma_f32_32x32x16_bf16 v[144:159], v[100:103], v[212:215], v[144:159]
    buffer_load_dwordx4 v[212:215], v114, s[20:23], s57 offen offset:1024 sc1
    s_waitcnt vmcnt(11) lgkmcnt(4)
    v_mfma_f32_32x32x16_bf16 v[128:143], v[104:107], v[216:219], v[128:143]
    ds_read_b64_tr_b16 v[96:97], v112 offset:32768
    ds_read_b64_tr_b16 v[98:99], v112 offset:34816
    ds_read_b64_tr_b16 v[100:101], v113 offset:32768
    ds_read_b64_tr_b16 v[102:103], v113 offset:34816
    v_mfma_f32_32x32x16_bf16 v[144:159], v[108:111], v[216:219], v[144:159]
    buffer_load_dwordx4 v[216:219], v114, s[20:23], s57 offen offset:2048 sc1
    s_waitcnt vmcnt(11) lgkmcnt(4)
    v_mfma_f32_32x32x16_bf16 v[128:143], v[240:243], v[220:223], v[128:143]
    ds_read_b64_tr_b16 v[104:105], v112 offset:36864
    ds_read_b64_tr_b16 v[106:107], v112 offset:38912
    ds_read_b64_tr_b16 v[108:109], v113 offset:36864
    ds_read_b64_tr_b16 v[110:111], v113 offset:38912
    v_mfma_f32_32x32x16_bf16 v[144:159], v[244:247], v[220:223], v[144:159]
    buffer_load_dwordx4 v[220:223], v114, s[20:23], s57 offen offset:3072 sc1
    s_add_u32 s57, s57, 4096
    s_waitcnt vmcnt(11) lgkmcnt(4)
    v_mfma_f32_32x32x16_bf16 v[128:143], v[96:99], v[176:179], v[128:143]
    ds_read_b64_tr_b16 v[240:241], v112 offset:40960
    ds_read_b64_tr_b16 v[242:243], v112 offset:43008
    ds_read_b64_tr_b16 v[244:245], v113 offset:40960
    ds_read_b64_tr_b16 v[246:247], v113 offset:43008
    v_mfma_f32_32x32x16_bf16 v[144:159], v[100:103], v[176:179], v[144:159]
    buffer_load_dwordx4 v[176:179], v114, s[20:23], s57 offen offset:0 sc1
    s_waitcnt vmcnt(11) lgkmcnt(4)
    v_mfma_f32_32x32x16_bf16 v[128:143], v[104:107], v[180:183], v[128:143]
    ds_read_b64_tr_b16 v[96:97], v112 offset:45056
    ds_read_b64_tr_b16 v[98:99], v112 offset:47104
    ds_read_b64_tr_b16 v[100:101], v113 offset:45056
    ds_read_b64_tr_b16 v[102:103], v113 offset:47104
    v_mfma_f32_32x32x16_bf16 v[144:159], v[108:111], v[180:183], v[144:159]
    buffer_load_dwordx4 v[180:183], v114, s[20:23], s57 offen offset:1024 sc1
    s_waitcnt vmcnt(11) lgkmcnt(4)
    v_mfma_f32_32x32x16_bf16 v[128:143], v[240:243], v[184:187], v[128:143]
    ds_read_b64_tr_b16 v[104:105], v112 offset:49152
    ds_read_b64_tr_b16 v[106:107], v112 offset:51200
    ds_read_b64_tr_b16 v[108:109], v113 offset:49152
    ds_read_b64_tr_b16 v[110:111], v113 offset:51200
    v_mfma_f32_32x32x16_bf16 v[144:159], v[244:247], v[184:187], v[144:159]
    buffer_load_dwordx4 v[184:187], v114, s[20:23], s57 offen offset:2048 sc1
    s_waitcnt vmcnt(11) lgkmcnt(4)
    v_mfma_f32_32x32x16_bf16 v[128:143], v[96:99], v[188:191], v[128:143]
    ds_read_b64_tr_b16 v[240:241], v112 offset:53248
    ds_read_b64_tr_b16 v[242:243], v112 offset:55296
    ds_read_b64_tr_b16 v[244:245], v113 offset:53248
    ds_read_b64_tr_b16 v[246:247], v113 offset:55296
    v_mfma_f32_32x32x16_bf16 v[144:159], v[100:103], v[188:191], v[144:159]
    buffer_load_dwordx4 v[188:191], v114, s[20:23], s57 offen offset:3072 sc1
    s_add_u32 s57, s57, 4096
    s_waitcnt vmcnt(11) lgkmcnt(4)
    v_mfma_f32_32x32x16_bf16 v[128:143], v[104:107], v[192:195], v[128:143]
    ds_read_b64_tr_b16 v[96:97], v112 offset:57344
    ds_read_b64_tr_b16 v[98:99], v112 offset:59392
    ds_read_b64_tr_b16 v[100:101], v113 offset:57344
    ds_read_b64_tr_b16 v[102:103], v113 offset:59392
    v_mfma_f32_32x32x16_bf16 v[144:159], v[108:111], v[192:195], v[144:159]
    buffer_load_dwordx4 v[192:195], v114, s[20:23], s57 offen offset:0 sc1
    s_waitcnt vmcnt(11) lgkmcnt(4)
    v_mfma_f32_32x32x16_bf16 v[128:143], v[240:243], v[196:199], v[128:143]
    ds_read_b64_tr_b16 v[104:105], v112 offset:61440
    ds_read_b64_tr_b16 v[106:107], v112 offset:63488
    ds_read_b64_tr_b16 v[108:109], v113 offset:61440
    ds_read_b64_tr_b16 v[110:111], v113 offset:63488
    v_mfma_f32_32x32x16_bf16 v[144:159], v[244:247], v[196:199], v[144:159]
    buffer_load_dwordx4 v[196:199], v114, s[20:23], s57 offen offset:1024 sc1
    s_waitcnt vmcnt(11) lgkmcnt(4)
    v_mfma_f32_32x32x16_bf16 v[128:143], v[96:99], v[200:203], v[128:143]
    v_add_u32 v112, 0x10000, v112
    v_add_u32 v113, 0x10000, v113
    ds_read_b64_tr_b16 v[240:241], v112 offset:0
    ds_read_b64_tr_b16 v[242:243], v112 offset:2048
    ds_read_b64_tr_b16 v[244:245], v113 offset:0
    ds_read_b64_tr_b16 v[246:247], v113 offset:2048
    v_mfma_f32_32x32x16_bf16 v[144:159], v[100:103], v[200:203], v[144:159]
    buffer_load_dwordx4 v[200:203], v114, s[20:23], s57 offen offset:2048 sc1
    s_waitcnt vmcnt(11) lgkmcnt(4)
    v_mfma_f32_32x32x16_bf16 v[128:143], v[104:107], v[204:207], v[128:143]
    ds_read_b64_tr_b16 v[96:97], v112 offset:4096
    ds_read_b64_tr_b16 v[98:99], v112 offset:6144
    ds_read_b64_tr_b16 v[100:101], v113 offset:4096
    ds_read_b64_tr_b16 v[102:103], v113 offset:6144
    v_mfma_f32_32x32x16_bf16 v[144:159], v[108:111], v[204:207], v[144:159]
    buffer_load_dwordx4 v[204:207], v114, s[20:23], s57 offen offset:3072 sc1
    s_add_u32 s57, s57, 4096
    s_waitcnt vmcnt(11) lgkmcnt(4)
    v_mfma_f32_32x32x16_bf16 v[128:143], v[240:243], v[208:211], v[128:143]
    ds_read_b64_tr_b16 v[104:105], v112 offset:8192
    ds_read_b64_tr_b16 v[106:107], v112 offset:10240
    ds_read_b64_tr_b16 v[108:109], v113 offset:8192
    ds_read_b64_tr_b16 v[110:111], v113 offset:10240
    v_mfma_f32_32x32x16_bf16 v[144:159], v[244:247], v[208:211], v[144:159]
    buffer_load_dwordx4 v[208:211], v114, s[20:23], s57 offen offset:0 sc1
    s_waitcnt vmcnt(11) lgkmcnt(4)
    v_mfma_f32_32x32x16_bf16 v[128:143], v[96:99], v[212:215], v[128:143]
    ds_read_b64_tr_b16 v[240:241], v112 offset:12288
    ds_read_b64_tr_b16 v[242:243], v112 offset:14336
    ds_read_b64_tr_b16 v[244:245], v113 offset:12288
    ds_read_b64_tr_b16 v[246:247], v113 offset:14336
    v_mfma_f32_32x32x16_bf16 v[144:159], v[100:103], v[212:215], v[144:159]
    buffer_load_dwordx4 v[212:215], v114, s[20:23], s57 offen offset:1024 sc1
    s_waitcnt vmcnt(11) lgkmcnt(4)
    v_mfma_f32_32x32x16_bf16 v[128:143], v[104:107], v[216:219], v[128:143]
    ds_read_b64_tr_b16 v[96:97], v112 offset:20480
    ds_read_b64_tr_b16 v[98:99], v112 offset:22528
    ds_read_b64_tr_b16 v[100:101], v113 offset:20480
    ds_read_b64_tr_b16 v[102:103], v113 offset:22528
    v_mfma_f32_32x32x16_bf16 v[144:159], v[108:111], v[216:219], v[144:159]
    buffer_load_dwordx4 v[216:219], v114, s[20:23], s57 offen offset:2048 sc1
    s_waitcnt vmcnt(11) lgkmcnt(4)
    v_mfma_f32_32x32x16_bf16 v[128:143], v[240:243], v[220:223], v[128:143]
    ds_read_b64_tr_b16 v[104:105], v112 offset:24576
    ds_read_b64_tr_b16 v[106:107], v112 offset:26624
    ds_read_b64_tr_b16 v[108:109], v113 offset:24576
    ds_read_b64_tr_b16 v[110:111], v113 offset:26624
    v_mfma_f32_32x32x16_bf16 v[144:159], v[244:247], v[220:223], v[144:159]
    buffer_load_dwordx4 v[220:223], v114, s[20:23], s57 offen offset:3072 sc1
    s_add_u32 s57, s57, 4096
    s_waitcnt vmcnt(11) lgkmcnt(4)
    v_mfma_f32_32x32x16_bf16 v[128:143], v[96:99], v[176:179], v[128:143]
    ds_read_b64_tr_b16 v[240:241], v112 offset:28672
    ds_read_b64_tr_b16 v[242:243], v112 offset:30720
    ds_read_b64_tr_b16 v[244:245], v113 offset:28672
    ds_read_b64_tr_b16 v[246:247], v113 offset:30720
    v_mfma_f32_32x32x16_bf16 v[144:159], v[100:103], v[176:179], v[144:159]
    buffer_load_dwordx4 v[176:179], v114, s[20:23], s57 offen offset:0 sc1
    s_waitcnt vmcnt(11) lgkmcnt(4)
    v_mfma_f32_32x32x16_bf16 v[128:143], v[104:107], v[180:183], v[128:143]
    s_barrier
    v_add_u32 v112, 0xfffe0000, v112
    v_add_u32 v113, 0xfffe0000, v113
    ds_read_b64_tr_b16 v[96:97], v112 offset:0
    ds_read_b64_tr_b16 v[98:99], v112 offset:2048
    ds_read_b64_tr_b16 v[100:101], v113 offset:0
    ds_read_b64_tr_b16 v[102:103], v113 offset:2048
    v_mfma_f32_32x32x16_bf16 v[144:159], v[108:111], v[180:183], v[144:159]
    buffer_load_dwordx4 v[180:183], v114, s[20:23], s57 offen offset:1024 sc1
    s_waitcnt vmcnt(11) lgkmcnt(4)
    v_mfma_f32_32x32x16_bf16 v[128:143], v[240:243], v[184:187], v[128:143]
    ds_read_b64_tr_b16 v[104:105], v112 offset:4096
    ds_read_b64_tr_b16 v[106:107], v112 offset:6144
    ds_read_b64_tr_b16 v[108:109], v113 offset:4096
    ds_read_b64_tr_b16 v[110:111], v113 offset:6144
    v_mfma_f32_32x32x16_bf16 v[144:159], v[244:247], v[184:187], v[144:159]
    buffer_load_dwordx4 v[184:187], v114, s[20:23], s57 offen offset:2048 sc1
    s_waitcnt vmcnt(11) lgkmcnt(4)
    v_mfma_f32_32x32x16_bf16 v[128:143], v[96:99], v[188:191], v[128:143]
    ds_read_b64_tr_b16 v[240:241], v112 offset:8192
    ds_read_b64_tr_b16 v[242:243], v112 offset:10240
    ds_read_b64_tr_b16 v[244:245], v113 offset:8192
    ds_read_b64_tr_b16 v[246:247], v113 offset:10240
    v_mfma_f32_32x32x16_bf16 v[144:159], v[100:103], v[188:191], v[144:159]
    buffer_load_dwordx4 v[188:191], v114, s[20:23], s57 offen offset:3072 sc1
    s_add_u32 s57, s57, 4096
    s_waitcnt vmcnt(11) lgkmcnt(4)
    v_mfma_f32_32x32x16_bf16 v[128:143], v[104:107], v[192:195], v[128:143]
    ds_read_b64_tr_b16 v[96:97], v112 offset:12288
    ds_read_b64_tr_b16 v[98:99], v112 offset:14336
    ds_read_b64_tr_b16 v[100:101], v113 offset:12288
    ds_read_b64_tr_b16 v[102:103], v113 offset:14336
    v_mfma_f32_32x32x16_bf16 v[144:159], v[108:111], v[192:195], v[144:159]
    buffer_load_dwordx4 v[192:195], v114, s[20:23], s57 offen offset:0 sc1
    s_waitcnt vmcnt(11) lgkmcnt(4)
    v_mfma_f32_32x32x16_bf16 v[128:143], v[240:243], v[196:199], v[128:143]
    ds_read_b64_tr_b16 v[104:105], v112 offset:16384
    ds_read_b64_tr_b16 v[106:107], v112 offset:18432
    ds_read_b64_tr_b16 v[108:109], v113 offset:16384
    ds_read_b64_tr_b16 v[110:111], v113 offset:18432
    v_mfma_f32_32x32x16_bf16 v[144:159], v[244:247], v[196:199], v[144:159]
    buffer_load_dwordx4 v[196:199], v114, s[20:23], s57 offen offset:1024 sc1
    s_waitcnt vmcnt(11) lgkmcnt(4)
    v_mfma_f32_32x32x16_bf16 v[128:143], v[96:99], v[200:203], v[128:143]
    ds_read_b64_tr_b16 v[240:241], v112 offset:20480
    ds_read_b64_tr_b16 v[242:243], v112 offset:22528
    ds_read_b64_tr_b16 v[244:245], v113 offset:20480
    ds_read_b64_tr_b16 v[246:247], v113 offset:22528
    v_mfma_f32_32x32x16_bf16 v[144:159], v[100:103], v[200:203], v[144:159]
    buffer_load_dwordx4 v[200:203], v114, s[20:23], s57 offen offset:2048 sc1
    s_waitcnt vmcnt(11) lgkmcnt(4)
    v_mfma_f32_32x32x16_bf16 v[128:143], v[104:107], v[204:207], v[128:143]
    ds_read_b64_tr_b16 v[96:97], v112 offset:24576
    ds_read_b64_tr_b16 v[98:99], v112 offset:26624
    ds_read_b64_tr_b16 v[100:101], v113 offset:24576
    ds_read_b64_tr_b16 v[102:103], v113 offset:26624
    v_mfma_f32_32x32x16_bf16 v[144:159], v[108:111], v[204:207], v[144:159]
    buffer_load_dwordx4 v[204:207], v114, s[20:23], s57 offen offset:3072 sc1
    s_add_u32 s57, s57, 4096
    s_waitcnt vmcnt(11) lgkmcnt(4)
    v_mfma_f32_32x32x16_bf16 v[128:143], v[240:243], v[208:211], v[128:143]
    s_barrier
    ds_read_b64_tr_b16 v[104:105], v112 offset:28672
    ds_read_b64_tr_b16 v[106:107], v112 offset:30720
    ds_read_b64_tr_b16 v[108:109], v113 offset:28672
    ds_read_b64_tr_b16 v[110:111], v113 offset:30720
    v_mfma_f32_32x32x16_bf16 v[144:159], v[244:247], v[208:211], v[144:159]
    s_waitcnt vmcnt(10) lgkmcnt(4)
    v_mfma_f32_32x32x16_bf16 v[128:143], v[96:99], v[212:215], v[128:143]
    ds_read_b64_tr_b16 v[240:241], v112 offset:32768
    ds_read_b64_tr_b16 v[242:243], v112 offset:34816
    ds_read_b64_tr_b16 v[244:245], v113 offset:32768
    ds_read_b64_tr_b16 v[246:247], v113 offset:34816
    v_mfma_f32_32x32x16_bf16 v[144:159], v[100:103], v[212:215], v[144:159]
    s_waitcnt vmcnt(9) lgkmcnt(4)
    v_mfma_f32_32x32x16_bf16 v[128:143], v[104:107], v[216:219], v[128:143]
    ds_read_b64_tr_b16 v[96:97], v112 offset:36864
    ds_read_b64_tr_b16 v[98:99], v112 offset:38912
    ds_read_b64_tr_b16 v[100:101], v113 offset:36864
    ds_read_b64_tr_b16 v[102:103], v113 offset:38912
    v_mfma_f32_32x32x16_bf16 v[144:159], v[108:111], v[216:219], v[144:159]
    s_waitcnt vmcnt(8) lgkmcnt(4)
    v_mfma_f32_32x32x16_bf16 v[128:143], v[240:243], v[220:223], v[128:143]
    ds_read_b64_tr_b16 v[104:105], v112 offset:40960
    ds_read_b64_tr_b16 v[106:107], v112 offset:43008
    ds_read_b64_tr_b16 v[108:109], v113 offset:40960
    ds_read_b64_tr_b16 v[110:111], v113 offset:43008
    v_mfma_f32_32x32x16_bf16 v[144:159], v[244:247], v[220:223], v[144:159]
    s_waitcnt vmcnt(7) lgkmcnt(4)
    v_mfma_f32_32x32x16_bf16 v[128:143], v[96:99], v[176:179], v[128:143]
    ds_read_b64_tr_b16 v[240:241], v112 offset:45056
    ds_read_b64_tr_b16 v[242:243], v112 offset:47104
    ds_read_b64_tr_b16 v[244:245], v113 offset:45056
    ds_read_b64_tr_b16 v[246:247], v113 offset:47104
    v_mfma_f32_32x32x16_bf16 v[144:159], v[100:103], v[176:179], v[144:159]
    s_waitcnt vmcnt(6) lgkmcnt(4)
    v_mfma_f32_32x32x16_bf16 v[128:143], v[104:107], v[180:183], v[128:143]
    ds_read_b64_tr_b16 v[96:97], v112 offset:49152
    ds_read_b64_tr_b16 v[98:99], v112 offset:51200
    ds_read_b64_tr_b16 v[100:101], v113 offset:49152
    ds_read_b64_tr_b16 v[102:103], v113 offset:51200
    v_mfma_f32_32x32x16_bf16 v[144:159], v[108:111], v[180:183], v[144:159]
    s_waitcnt vmcnt(5) lgkmcnt(4)
    v_mfma_f32_32x32x16_bf16 v[128:143], v[240:243], v[184:187], v[128:143]
    ds_read_b64_tr_b16 v[104:105], v112 offset:53248
    ds_read_b64_tr_b16 v[106:107], v112 offset:55296
    ds_read_b64_tr_b16 v[108:109], v113 offset:53248
    ds_read_b64_tr_b16 v[110:111], v113 offset:55296
    v_mfma_f32_32x32x16_bf16 v[144:159], v[244:247], v[184:187], v[144:159]
    s_waitcnt vmcnt(4) lgkmcnt(4)
    v_mfma_f32_32x32x16_bf16 v[128:143], v[96:99], v[188:191], v[128:143]
    ds_read_b64_tr_b16 v[240:241], v112 offset:57344
    ds_read_b64_tr_b16 v[242:243], v112 offset:59392
    ds_read_b64_tr_b16 v[244:245], v113 offset:57344
    ds_read_b64_tr_b16 v[246:247], v113 offset:59392
    v_mfma_f32_32x32x16_bf16 v[144:159], v[100:103], v[188:191], v[144:159]
    s_waitcnt vmcnt(3) lgkmcnt(4)
    v_mfma_f32_32x32x16_bf16 v[128:143], v[104:107], v[192:195], v[128:143]
    ds_read_b64_tr_b16 v[96:97], v112 offset:61440
    ds_read_b64_tr_b16 v[98:99], v112 offset:63488
    ds_read_b64_tr_b16 v[100:101], v113 offset:61440
    ds_read_b64_tr_b16 v[102:103], v113 offset:63488
    v_mfma_f32_32x32x16_bf16 v[144:159], v[108:111], v[192:195], v[144:159]
    s_waitcnt vmcnt(2) lgkmcnt(4)
    v_mfma_f32_32x32x16_bf16 v[128:143], v[240:243], v[196:199], v[128:143]
    v_add_u32 v112, 0x10000, v112
    v_add_u32 v113, 0x10000, v113
    ds_read_b64_tr_b16 v[104:105], v112 offset:0
    ds_read_b64_tr_b16 v[106:107], v112 offset:2048
    ds_read_b64_tr_b16 v[108:109], v113 offset:0
    ds_read_b64_tr_b16 v[110:111], v113 offset:2048
    v_mfma_f32_32x32x16_bf16 v[144:159], v[244:247], v[196:199], v[144:159]
    s_waitcnt vmcnt(1) lgkmcnt(4)
    v_mfma_f32_32x32x16_bf16 v[128:143], v[96:99], v[200:203], v[128:143]
    v_mfma_f32_32x32x16_bf16 v[144:159], v[100:103], v[200:203], v[144:159]
    s_waitcnt vmcnt(0) lgkmcnt(0)
    v_mfma_f32_32x32x16_bf16 v[144:159], v[108:111], v[204:207], v[144:159]
    v_mfma_f32_32x32x16_bf16 v[128:143], v[104:107], v[204:207], v[128:143]
    s_nop 7
    s_nop 2
    ds_write_b128 v91, v[144:147] offset:0
    ds_write_b128 v91, v[148:151] offset:1024
    ds_write_b128 v91, v[152:155] offset:2048
    ds_write_b128 v91, v[156:159] offset:3072
    s_waitcnt lgkmcnt(0)
    s_barrier
    ds_read_b128 v[192:195], v92 offset:0
    ds_read_b128 v[196:199], v92 offset:1024
    ds_read_b128 v[200:203], v92 offset:2048
    ds_read_b128 v[204:207], v92 offset:3072
    ds_read_b128 v[0:3], v116 offset:0
    ds_read_b128 v[4:7], v116 offset:2048
    ds_read_b128 v[8:11], v116 offset:4096
    ds_read_b128 v[12:15], v116 offset:6144
    ds_read_b128 v[16:19], v116 offset:8192
    ds_read_b128 v[20:23], v116 offset:10240
    ds_read_b128 v[24:27], v116 offset:12288
    ds_read_b128 v[28:31], v116 offset:14336
    s_waitcnt lgkmcnt(8)
.p2align 3
    v_pk_add_f32 v[128:129], v[128:129], v[192:193]
    v_pk_add_f32 v[130:131], v[130:131], v[194:195]
    v_pk_add_f32 v[132:133], v[132:133], v[196:197]
    v_pk_add_f32 v[134:135], v[134:135], v[198:199]
    v_pk_add_f32 v[136:137], v[136:137], v[200:201]
    v_pk_add_f32 v[138:139], v[138:139], v[202:203]
    v_pk_add_f32 v[140:141], v[140:141], v[204:205]
    v_pk_add_f32 v[142:143], v[142:143], v[206:207]
    v_pk_mul_f32 v[208:209], v[128:129], v[88:89] op_sel:[0,1] op_sel_hi:[1,1]
    v_pk_mul_f32 v[210:211], v[130:131], v[88:89] op_sel:[0,1] op_sel_hi:[1,1]
    v_pk_mul_f32 v[212:213], v[132:133], v[88:89] op_sel:[0,1] op_sel_hi:[1,1]
    v_pk_mul_f32 v[214:215], v[134:135], v[88:89] op_sel:[0,1] op_sel_hi:[1,1]
    v_pk_mul_f32 v[216:217], v[136:137], v[88:89] op_sel:[0,1] op_sel_hi:[1,1]
    v_pk_mul_f32 v[218:219], v[138:139], v[88:89] op_sel:[0,1] op_sel_hi:[1,1]
    v_pk_mul_f32 v[220:221], v[140:141], v[88:89] op_sel:[0,1] op_sel_hi:[1,1]
    v_pk_mul_f32 v[222:223], v[142:143], v[88:89] op_sel:[0,1] op_sel_hi:[1,1]
    v_pk_mul_f32 v[128:129], v[128:129], v[88:89] op_sel_hi:[1,0]
    v_pk_mul_f32 v[130:131], v[130:131], v[88:89] op_sel_hi:[1,0]
    v_pk_mul_f32 v[132:133], v[132:133], v[88:89] op_sel_hi:[1,0]
    v_pk_mul_f32 v[134:135], v[134:135], v[88:89] op_sel_hi:[1,0]
    v_pk_mul_f32 v[136:137], v[136:137], v[88:89] op_sel_hi:[1,0]
    v_pk_mul_f32 v[138:139], v[138:139], v[88:89] op_sel_hi:[1,0]
    v_pk_mul_f32 v[140:141], v[140:141], v[88:89] op_sel_hi:[1,0]
    v_pk_mul_f32 v[142:143], v[142:143], v[88:89] op_sel_hi:[1,0]
    s_waitcnt lgkmcnt(0)
    v_mfma_f32_32x32x16_bf16 v[160:175], v[0:3], v[32:35], 0
    v_exp_f32 v208, v208
    v_exp_f32 v209, v209
    v_exp_f32 v210, v210
    v_mfma_f32_32x32x16_bf16 v[160:175], v[4:7], v[36:39], v[160:175]
    v_exp_f32 v211, v211
    v_exp_f32 v212, v212
    v_exp_f32 v213, v213
    v_mfma_f32_32x32x16_bf16 v[160:175], v[8:11], v[40:43], v[160:175]
    v_exp_f32 v214, v214
    v_exp_f32 v215, v215
    v_exp_f32 v216, v216
    v_mfma_f32_32x32x16_bf16 v[160:175], v[12:15], v[44:47], v[160:175]
    v_exp_f32 v217, v217
    v_exp_f32 v218, v218
    v_exp_f32 v219, v219
    v_mfma_f32_32x32x16_bf16 v[160:175], v[16:19], v[48:51], v[160:175]
    v_exp_f32 v220, v220
    v_exp_f32 v221, v221
    v_exp_f32 v222, v222
    v_mfma_f32_32x32x16_bf16 v[160:175], v[20:23], v[52:55], v[160:175]
    v_exp_f32 v223, v223
    v_add_f32 v208, 1.0, v208
    v_add_f32 v209, 1.0, v209
    v_mfma_f32_32x32x16_bf16 v[160:175], v[24:27], v[56:59], v[160:175]
    v_add_f32 v210, 1.0, v210
    v_add_f32 v211, 1.0, v211
    v_add_f32 v212, 1.0, v212
    v_add_f32 v213, 1.0, v213
    v_add_f32 v214, 1.0, v214
    v_add_f32 v215, 1.0, v215
    v_mfma_f32_32x32x16_bf16 v[160:175], v[28:31], v[60:63], v[160:175]
    v_add_f32 v216, 1.0, v216
    v_add_f32 v217, 1.0, v217
    v_add_f32 v218, 1.0, v218
    v_add_f32 v219, 1.0, v219
    v_add_f32 v220, 1.0, v220
    v_add_f32 v221, 1.0, v221
    v_add_f32 v222, 1.0, v222
    v_add_f32 v223, 1.0, v223
    v_rcp_f32 v208, v208
    v_rcp_f32 v209, v209
    v_rcp_f32 v210, v210
    v_rcp_f32 v211, v211
    v_rcp_f32 v212, v212
    v_rcp_f32 v213, v213
    v_rcp_f32 v214, v214
    v_rcp_f32 v215, v215
    v_rcp_f32 v216, v216
    v_rcp_f32 v217, v217
    v_rcp_f32 v218, v218
    v_rcp_f32 v219, v219
    v_rcp_f32 v220, v220
    v_rcp_f32 v221, v221
    v_rcp_f32 v222, v222
    v_rcp_f32 v223, v223
.p2align 3
    v_pk_mul_f32 v[128:129], v[128:129], v[208:209]
    v_pk_mul_f32 v[130:131], v[130:131], v[210:211]
    v_pk_mul_f32 v[132:133], v[132:133], v[212:213]
    v_pk_mul_f32 v[134:135], v[134:135], v[214:215]
    v_pk_mul_f32 v[136:137], v[136:137], v[216:217]
    v_pk_mul_f32 v[138:139], v[138:139], v[218:219]
    v_pk_mul_f32 v[140:141], v[140:141], v[220:221]
    v_pk_mul_f32 v[142:143], v[142:143], v[222:223]
    v_pk_fma_f32 v[128:129], v[128:129], v[160:161], v[64:65]
    v_pk_fma_f32 v[130:131], v[130:131], v[162:163], v[66:67]
    v_pk_fma_f32 v[132:133], v[132:133], v[164:165], v[68:69]
    v_pk_fma_f32 v[134:135], v[134:135], v[166:167], v[70:71]
    v_pk_fma_f32 v[136:137], v[136:137], v[168:169], v[72:73]
    v_pk_fma_f32 v[138:139], v[138:139], v[170:171], v[74:75]
    v_pk_fma_f32 v[140:141], v[140:141], v[172:173], v[76:77]
    v_pk_fma_f32 v[142:143], v[142:143], v[174:175], v[78:79]
    v_cvt_pk_bf16_f32 v208, v128, v129
    v_cvt_pk_bf16_f32 v209, v130, v131
    v_cvt_pk_bf16_f32 v210, v132, v133
    v_cvt_pk_bf16_f32 v211, v134, v135
    v_cvt_pk_bf16_f32 v212, v136, v137
    v_cvt_pk_bf16_f32 v213, v138, v139
    v_cvt_pk_bf16_f32 v214, v140, v141
    v_cvt_pk_bf16_f32 v215, v142, v143
    buffer_store_dwordx4 v[208:211], v115, s[24:27], s56 offen
    buffer_store_dwordx4 v[212:215], v115, s[24:27], s56 offen offset:16
    s_endpgm
.p2align 12
CDFT:
    v_bfe_u32 v4, v0, 1, 3
    v_lshlrev_b32 v5, 7, v2
    v_add_u32 v5, 81920, v5
    v_add_u32 v6, 0, v3
    v_xor_b32 v6, v6, v4
    v_lshl_add_u32 v112, v6, 4, v5
    v_add_u32 v6, 2, v3
    v_xor_b32 v6, v6, v4
    v_lshl_add_u32 v113, v6, 4, v5
    v_add_u32 v6, 4, v3
    v_xor_b32 v6, v6, v4
    v_lshl_add_u32 v114, v6, 4, v5
    v_add_u32 v6, 6, v3
    v_xor_b32 v6, v6, v4
    v_lshl_add_u32 v115, v6, 4, v5
    v_bfe_u32 v4, v0, 2, 2
    v_lshlrev_b32 v116, 12, v3
    v_lshl_add_u32 v116, v4, 8, v116
    v_xor_b32 v4, s36, v4
    v_lshl_add_u32 v116, v4, 6, v116
    v_bfe_u32 v4, v0, 4, 1
    v_xor_b32 v4, v4, v3
    v_lshl_add_u32 v116, v4, 5, v116
    v_and_b32 v4, 3, v0
    v_lshl_add_u32 v116, v4, 3, v116
    v_add_u32 v116, 49152, v116
    v_lshlrev_b32 v123, 4, v3
    v_add_u32 v123, 149504, v123
    v_mov_b32 v124, 150528
    s_lshl_b32 s64, s37, 12
    s_and_b32 s65, s38, 1
    s_lshl_b32 s66, s65, 11
    s_add_u32 s64, s64, s66
    s_lshl_b32 s66, s36, 9
    s_add_u32 s64, s64, s66
    s_add_u32 s62, s64, 8388608
    v_and_b32 v2, 31, v117
    v_cvt_f32_u32 v3, v2
    v_mul_f32 v3, 0x3a000000, v3
    s_and_b32 s64, s36, 1
    s_lshr_b32 s65, s36, 1
    s_lshl_b32 s65, s65, 5
    s_add_u32 s64, s64, s65
    s_lshl_b32 s65, s37, 1
    s_add_u32 s64, s64, s65
    v_lshrrev_b32 v4, 5, v117
    v_lshl_add_u32 v4, v4, 8, s64
    v_cvt_f32_u32 v4, v4
    v_mul_f32 v4, v3, v4
    v_and_b32 v5, 1, v2
    v_mul_u32_u24 v5, 0x8000, v5
    v_lshl_or_b32 v5, v5, 16, v5
    v_fmamk_f32 v8, v3, 0x0, v4
    v_fmamk_f32 v9, v3, 0x42800000, v4
    v_fmamk_f32 v10, v3, 0x43000000, v4
    v_fmamk_f32 v11, v3, 0x43400000, v4
    v_fmamk_f32 v12, v3, 0x44000000, v4
    v_fmamk_f32 v13, v3, 0x44100000, v4
    v_fmamk_f32 v14, v3, 0x44200000, v4
    v_fmamk_f32 v15, v3, 0x44300000, v4
    v_fract_f32 v8, v8
    v_fract_f32 v9, v9
    v_fract_f32 v10, v10
    v_fract_f32 v11, v11
    v_fract_f32 v12, v12
    v_fract_f32 v13, v13
    v_fract_f32 v14, v14
    v_fract_f32 v15, v15
    v_cos_f32 v16, v8
    v_sin_f32 v24, v8
    v_cos_f32 v17, v9
    v_sin_f32 v25, v9
    v_cos_f32 v18, v10
    v_sin_f32 v26, v10
    v_cos_f32 v19, v11
    v_sin_f32 v27, v11
    v_cos_f32 v20, v12
    v_sin_f32 v28, v12
    v_cos_f32 v21, v13
    v_sin_f32 v29, v13
    v_cos_f32 v22, v14
    v_sin_f32 v30, v14
    v_cos_f32 v23, v15
    v_sin_f32 v31, v15
    s_nop 0
    v_cvt_pk_bf16_f32 v32, v16, v17
    v_cvt_pk_bf16_f32 v40, v24, v25
    v_cvt_pk_bf16_f32 v33, v18, v19
    v_cvt_pk_bf16_f32 v41, v26, v27
    v_cvt_pk_bf16_f32 v34, v20, v21
    v_cvt_pk_bf16_f32 v42, v28, v29
    v_cvt_pk_bf16_f32 v35, v22, v23
    v_cvt_pk_bf16_f32 v43, v30, v31
    v_xor_b32 v36, v5, v32
    v_xor_b32 v44, v5, v40
    v_xor_b32 v37, v5, v33
    v_xor_b32 v45, v5, v41
    v_xor_b32 v38, v5, v34
    v_xor_b32 v46, v5, v42
    v_xor_b32 v39, v5, v35
    v_xor_b32 v47, v5, v43
    s_lshl_b32 s64, s36, 12
    s_add_u32 s64, s64, 147456
    v_lshl_add_u32 v6, v117, 4, s64
    ds_write_b128 v6, v[32:35] offset:0
    ds_write_b128 v6, v[36:39] offset:1024
    ds_write_b128 v6, v[40:43] offset:2048
    ds_write_b128 v6, v[44:47] offset:3072
    s_cmp_eq_u32 s38, 14
    s_cselect_b32 s68, 1, 0
    s_cmp_eq_u32 s36, 0
    s_cselect_b32 s68, s68, 0
    s_mov_b32 s69, s68
    v_mov_b32 v118, 0xbf803f80
    v_lshlrev_b32 v119, 4, v117
    v_add_u32 v119, 147456, v119
    s_waitcnt lgkmcnt(0)
    s_barrier
    ds_read_b128 v[0:3], v119 offset:0
    ds_read_b128 v[4:7], v119 offset:1024
    ds_read_b128 v[8:11], v119 offset:2048
    ds_read_b128 v[12:15], v119 offset:3072
    ds_read_b128 v[16:19], v119 offset:4096
    ds_read_b128 v[20:23], v119 offset:5120
    ds_read_b128 v[24:27], v119 offset:6144
    ds_read_b128 v[28:31], v119 offset:7168
    ds_read_b128 v[32:35], v119 offset:8192
    ds_read_b128 v[36:39], v119 offset:9216
    ds_read_b128 v[40:43], v119 offset:10240
    ds_read_b128 v[44:47], v119 offset:11264
    ds_read_b128 v[48:51], v119 offset:12288
    ds_read_b128 v[52:55], v119 offset:13312
    ds_read_b128 v[56:59], v119 offset:14336
    ds_read_b128 v[60:63], v119 offset:15360
    ds_read_b64_tr_b16 v[96:97], v116 offset:0
    ds_read_b64_tr_b16 v[98:99], v116 offset:2048
    ds_read_b64_tr_b16 v[100:101], v116 offset:1024
    ds_read_b64_tr_b16 v[102:103], v116 offset:3072
    ds_read_b128 v[64:67], v112 offset:0
    ds_read_b128 v[68:71], v112 offset:4096
    ds_read_b128 v[72:75], v112 offset:8192
    ds_read_b128 v[76:79], v112 offset:12288
    s_mov_b32 s64, 8
    s_mov_b32 s66, 49152
    s_mov_b32 s67, 0xfffe8000
.p2align 3
MAIND:
    s_waitcnt lgkmcnt(0)
    v_mfma_f32_32x32x16_bf16 v[144:159], v[64:67], v[100:103], v[144:159]
    v_cndmask_b32 v96, v96, v118, s[68:69]
    v_cndmask_b32 v97, v97, v118, s[68:69]
    ds_read_b64_tr_b16 v[104:105], v116 offset:8192
    ds_read_b64_tr_b16 v[106:107], v116 offset:10240
    v_mfma_f32_32x32x16_bf16 v[176:191], v[68:71], v[100:103], v[176:191]
    v_cndmask_b32 v98, v98, v118, s[68:69]
    v_cndmask_b32 v99, v99, v118, s[68:69]
    ds_read_b64_tr_b16 v[108:109], v116 offset:9216
    ds_read_b64_tr_b16 v[110:111], v116 offset:11264
    v_mfma_f32_32x32x16_bf16 v[208:223], v[72:75], v[100:103], v[208:223]
    ds_read_b128 v[80:83], v113 offset:0
    ds_read_b128 v[84:87], v113 offset:4096
    v_mfma_f32_32x32x16_bf16 v[240:255], v[76:79], v[100:103], v[240:255]
    ds_read_b128 v[88:91], v113 offset:8192
    ds_read_b128 v[92:95], v113 offset:12288
    v_mfma_f32_32x32x16_bf16 v[128:143], v[64:67], v[96:99], v[128:143]
    v_mfma_f32_32x32x16_bf16 v[160:175], v[68:71], v[96:99], v[160:175]
    v_mfma_f32_32x32x16_bf16 v[192:207], v[72:75], v[96:99], v[192:207]
    v_mfma_f32_32x32x16_bf16 v[224:239], v[76:79], v[96:99], v[224:239]
    s_waitcnt lgkmcnt(0)
    v_mfma_f32_32x32x16_bf16 v[144:159], v[80:83], v[108:111], v[144:159]
    v_cndmask_b32 v104, v104, v118, s[68:69]
    v_cndmask_b32 v105, v105, v118, s[68:69]
    s_barrier
    v_mfma_f32_32x32x16_bf16 v[176:191], v[84:87], v[108:111], v[176:191]
    v_cndmask_b32 v106, v106, v118, s[68:69]
    v_cndmask_b32 v107, v107, v118, s[68:69]
    ds_read_b64_tr_b16 v[96:97], v116 offset:16384
    ds_read_b64_tr_b16 v[98:99], v116 offset:18432
    v_mfma_f32_32x32x16_bf16 v[208:223], v[88:91], v[108:111], v[208:223]
    ds_read_b64_tr_b16 v[100:101], v116 offset:17408
    ds_read_b64_tr_b16 v[102:103], v116 offset:19456
    v_mfma_f32_32x32x16_bf16 v[240:255], v[92:95], v[108:111], v[240:255]
    ds_read_b128 v[64:67], v114 offset:0
    ds_read_b128 v[68:71], v114 offset:4096
    v_mfma_f32_32x32x16_bf16 v[128:143], v[80:83], v[104:107], v[128:143]
    ds_read_b128 v[72:75], v114 offset:8192
    ds_read_b128 v[76:79], v114 offset:12288
    v_mfma_f32_32x32x16_bf16 v[160:175], v[84:87], v[104:107], v[160:175]
    v_mfma_f32_32x32x16_bf16 v[192:207], v[88:91], v[104:107], v[192:207]
    v_mfma_f32_32x32x16_bf16 v[224:239], v[92:95], v[104:107], v[224:239]
    s_waitcnt lgkmcnt(0)
    v_mfma_f32_32x32x16_bf16 v[144:159], v[64:67], v[100:103], v[144:159]
    v_cndmask_b32 v96, v96, v118, s[68:69]
    v_cndmask_b32 v97, v97, v118, s[68:69]
    ds_read_b64_tr_b16 v[104:105], v116 offset:24576
    ds_read_b64_tr_b16 v[106:107], v116 offset:26624
    v_mfma_f32_32x32x16_bf16 v[176:191], v[68:71], v[100:103], v[176:191]
    v_cndmask_b32 v98, v98, v118, s[68:69]
    v_cndmask_b32 v99, v99, v118, s[68:69]
    ds_read_b64_tr_b16 v[108:109], v116 offset:25600
    ds_read_b64_tr_b16 v[110:111], v116 offset:27648
    v_mfma_f32_32x32x16_bf16 v[208:223], v[72:75], v[100:103], v[208:223]
    ds_read_b128 v[80:83], v115 offset:0
    ds_read_b128 v[84:87], v115 offset:4096
    v_mfma_f32_32x32x16_bf16 v[240:255], v[76:79], v[100:103], v[240:255]
    ds_read_b128 v[88:91], v115 offset:8192
    ds_read_b128 v[92:95], v115 offset:12288
    v_mfma_f32_32x32x16_bf16 v[128:143], v[64:67], v[96:99], v[128:143]
    ds_read_b32 v119, v124
    v_mfma_f32_32x32x16_bf16 v[160:175], v[68:71], v[96:99], v[160:175]
    s_cmp_eq_u32 s66, 98304
    s_cselect_b32 s65, s67, 49152
    v_mfma_f32_32x32x16_bf16 v[192:207], v[72:75], v[96:99], v[192:207]
    s_add_u32 s66, s66, s65
    s_sub_u32 s64, s64, 1
    v_mfma_f32_32x32x16_bf16 v[224:239], v[76:79], v[96:99], v[224:239]
    s_cmp_eq_u32 s64, 0
    s_cbranch_scc1 LASTD
    s_waitcnt lgkmcnt(0)
    v_mfma_f32_32x32x16_bf16 v[144:159], v[80:83], v[108:111], v[144:159]
    v_cndmask_b32 v104, v104, v118, s[68:69]
    v_cndmask_b32 v105, v105, v118, s[68:69]
    v_add_u32 v116, s65, v116
    v_add_u32 v112, s65, v112
    s_barrier
    v_mfma_f32_32x32x16_bf16 v[176:191], v[84:87], v[108:111], v[176:191]
    v_cndmask_b32 v106, v106, v118, s[68:69]
    v_cndmask_b32 v107, v107, v118, s[68:69]
    ds_read_b64_tr_b16 v[96:97], v116 offset:0
    ds_read_b64_tr_b16 v[98:99], v116 offset:2048
    v_mfma_f32_32x32x16_bf16 v[208:223], v[88:91], v[108:111], v[208:223]
    ds_read_b64_tr_b16 v[100:101], v116 offset:1024
    ds_read_b64_tr_b16 v[102:103], v116 offset:3072
    v_mfma_f32_32x32x16_bf16 v[240:255], v[92:95], v[108:111], v[240:255]
    ds_read_b128 v[64:67], v112 offset:0
    ds_read_b128 v[68:71], v112 offset:4096
    v_mfma_f32_32x32x16_bf16 v[128:143], v[80:83], v[104:107], v[128:143]
    ds_read_b128 v[72:75], v112 offset:8192
    ds_read_b128 v[76:79], v112 offset:12288
    v_mfma_f32_32x32x16_bf16 v[160:175], v[84:87], v[104:107], v[160:175]
    v_add_u32 v113, s65, v113
    v_mfma_f32_32x32x16_bf16 v[192:207], v[88:91], v[104:107], v[192:207]
    v_add_u32 v114, s65, v114
    v_add_u32 v115, s65, v115
    v_mfma_f32_32x32x16_bf16 v[224:239], v[92:95], v[104:107], v[224:239]
    s_branch MAIND
LASTD:
    s_waitcnt lgkmcnt(0)
    v_mfma_f32_32x32x16_bf16 v[144:159], v[80:83], v[108:111], v[144:159]
    v_cndmask_b32 v104, v104, v118, s[68:69]
    v_cndmask_b32 v105, v105, v118, s[68:69]
    s_barrier
    v_readfirstlane_b32 s44, v119
    v_mfma_f32_32x32x16_bf16 v[176:191], v[84:87], v[108:111], v[176:191]
    v_cndmask_b32 v106, v106, v118, s[68:69]
    v_cndmask_b32 v107, v107, v118, s[68:69]
    v_and_b32 v100, 31, v117
    v_mfma_f32_32x32x16_bf16 v[208:223], v[88:91], v[108:111], v[208:223]
    ds_read_b128 v[124:127], v124
    ds_read_b128 v[64:67], v123 offset:0
    ds_read_b128 v[68:71], v123 offset:32
    v_lshrrev_b32 v101, 5, v117
    v_mfma_f32_32x32x16_bf16 v[240:255], v[92:95], v[108:111], v[240:255]
    ds_read_b128 v[72:75], v123 offset:64
    ds_read_b128 v[76:79], v123 offset:96
    v_mfma_f32_32x32x16_bf16 v[128:143], v[80:83], v[104:107], v[128:143]
    v_lshlrev_b32 v115, 16, v100
    v_mfma_f32_32x32x16_bf16 v[160:175], v[84:87], v[104:107], v[160:175]
    v_mfma_f32_32x32x16_bf16 v[192:207], v[88:91], v[104:107], v[192:207]
    v_lshl_add_u32 v115, v101, 5, v115
    v_mfma_f32_32x32x16_bf16 v[224:239], v[92:95], v[104:107], v[224:239]
    v_mov_b32 v114, v123
    buffer_load_dwordx4 v[80:83], v115, s[4:7], s56 offen
    buffer_load_dwordx4 v[84:87], v115, s[4:7], s56 offen offset:16
    s_waitcnt lgkmcnt(0)
    v_readfirstlane_b32 s59, v127
    s_nop 2
    v_pk_mul_f32 v[128:129], v[128:129], v[64:65]
    v_pk_mul_f32 v[130:131], v[130:131], v[66:67]
    v_pk_mul_f32 v[132:133], v[132:133], v[68:69]
    v_pk_mul_f32 v[134:135], v[134:135], v[70:71]
    v_pk_mul_f32 v[136:137], v[136:137], v[72:73]
    v_pk_mul_f32 v[138:139], v[138:139], v[74:75]
    v_pk_mul_f32 v[140:141], v[140:141], v[76:77]
    v_pk_mul_f32 v[142:143], v[142:143], v[78:79]
    v_cvt_pk_bf16_f32 v96, v128, v129
    v_cvt_pk_bf16_f32 v97, v130, v131
    v_cvt_pk_bf16_f32 v98, v132, v133
    v_cvt_pk_bf16_f32 v99, v134, v135
    v_cvt_pk_bf16_f32 v100, v136, v137
    v_cvt_pk_bf16_f32 v101, v138, v139
    v_cvt_pk_bf16_f32 v102, v140, v141
    v_cvt_pk_bf16_f32 v103, v142, v143
    v_pk_mul_f32 v[144:145], v[144:145], v[64:65]
    v_pk_mul_f32 v[146:147], v[146:147], v[66:67]
    v_pk_mul_f32 v[148:149], v[148:149], v[68:69]
    v_pk_mul_f32 v[150:151], v[150:151], v[70:71]
    v_pk_mul_f32 v[152:153], v[152:153], v[72:73]
    v_pk_mul_f32 v[154:155], v[154:155], v[74:75]
    v_pk_mul_f32 v[156:157], v[156:157], v[76:77]
    v_pk_mul_f32 v[158:159], v[158:159], v[78:79]
    ds_read_b128 v[64:67], v114 offset:128
    ds_read_b128 v[68:71], v114 offset:160
    ds_read_b128 v[72:75], v114 offset:192
    ds_read_b128 v[76:79], v114 offset:224
    v_cvt_pk_bf16_f32 v104, v144, v145
    v_cvt_pk_bf16_f32 v105, v146, v147
    v_cvt_pk_bf16_f32 v106, v148, v149
    v_cvt_pk_bf16_f32 v107, v150, v151
    v_cvt_pk_bf16_f32 v108, v152, v153
    v_cvt_pk_bf16_f32 v109, v154, v155
    v_cvt_pk_bf16_f32 v110, v156, v157
    v_cvt_pk_bf16_f32 v111, v158, v159
    s_waitcnt lgkmcnt(0)
    s_nop 1
    v_mfma_f32_32x32x16_bf16 v[128:143], v[8:11], v[104:107], 0
    v_mul_f32 v160, v160, v64
    v_mul_f32 v161, v161, v65
    v_mul_f32 v162, v162, v66
    v_mul_f32 v163, v163, v67
    v_mul_f32 v164, v164, v68
    v_mul_f32 v165, v165, v69
    v_mfma_f32_32x32x16_bf16 v[144:159], v[0:3], v[104:107], 0
    v_mul_f32 v166, v166, v70
    v_mul_f32 v167, v167, v71
    v_mul_f32 v168, v168, v72
    v_mul_f32 v169, v169, v73
    v_mul_f32 v170, v170, v74
    v_mul_f32 v171, v171, v75
    v_mfma_f32_32x32x16_bf16 v[128:143], v[12:15], v[108:111], v[128:143]
    v_mul_f32 v172, v172, v76
    v_mul_f32 v173, v173, v77
    v_mul_f32 v174, v174, v78
    v_mul_f32 v175, v175, v79
    v_cvt_pk_bf16_f32 v120, v160, v161
    v_cvt_pk_bf16_f32 v121, v162, v163
    v_mfma_f32_32x32x16_bf16 v[144:159], v[4:7], v[108:111], v[144:159]
    v_xor_b32 v8, 0x80008000, v8
    v_xor_b32 v9, 0x80008000, v9
    v_xor_b32 v10, 0x80008000, v10
    v_xor_b32 v11, 0x80008000, v11
    v_cvt_pk_bf16_f32 v122, v164, v165
    v_cvt_pk_bf16_f32 v123, v166, v167
    v_cvt_pk_bf16_f32 v124, v168, v169
    v_cvt_pk_bf16_f32 v125, v170, v171
    v_cvt_pk_bf16_f32 v126, v172, v173
    v_cvt_pk_bf16_f32 v127, v174, v175
    v_mfma_f32_32x32x16_bf16 v[128:143], v[0:3], v[96:99], v[128:143]
    v_xor_b32 v12, 0x80008000, v12
    v_xor_b32 v13, 0x80008000, v13
    v_xor_b32 v14, 0x80008000, v14
    v_xor_b32 v15, 0x80008000, v15
    v_mul_f32 v176, v176, v64
    v_mul_f32 v177, v177, v65
    v_mul_f32 v178, v178, v66
    v_mul_f32 v179, v179, v67
    v_mul_f32 v180, v180, v68
    v_mul_f32 v181, v181, v69
    v_mfma_f32_32x32x16_bf16 v[128:143], v[4:7], v[100:103], v[128:143]
    v_mul_f32 v182, v182, v70
    v_mul_f32 v183, v183, v71
    v_mul_f32 v184, v184, v72
    v_mul_f32 v185, v185, v73
    v_mul_f32 v186, v186, v74
    v_mfma_f32_32x32x16_bf16 v[144:159], v[8:11], v[96:99], v[144:159]
    v_mul_f32 v187, v187, v75
    v_mul_f32 v188, v188, v76
    v_mul_f32 v189, v189, v77
    v_mul_f32 v190, v190, v78
    v_mul_f32 v191, v191, v79
    ds_read_b128 v[64:67], v114 offset:256
    ds_read_b128 v[68:71], v114 offset:288
    ds_read_b128 v[72:75], v114 offset:320
    ds_read_b128 v[76:79], v114 offset:352
    v_mfma_f32_32x32x16_bf16 v[144:159], v[12:15], v[100:103], v[144:159]
    v_cvt_pk_bf16_f32 v0, v176, v177
    v_cvt_pk_bf16_f32 v1, v178, v179
    v_cvt_pk_bf16_f32 v2, v180, v181
    v_cvt_pk_bf16_f32 v3, v182, v183
    v_cvt_pk_bf16_f32 v4, v184, v185
    v_cvt_pk_bf16_f32 v5, v186, v187
    v_cvt_pk_bf16_f32 v6, v188, v189
    v_cvt_pk_bf16_f32 v7, v190, v191
    s_waitcnt lgkmcnt(0)
    s_nop 1
    v_mfma_f32_32x32x16_bf16 v[160:175], v[24:27], v[0:3], 0
    v_mul_f32 v192, v192, v64
    v_mul_f32 v193, v193, v65
    v_mul_f32 v194, v194, v66
    v_mul_f32 v195, v195, v67
    v_mul_f32 v196, v196, v68
    v_mul_f32 v197, v197, v69
    v_mfma_f32_32x32x16_bf16 v[176:191], v[16:19], v[0:3], 0
    v_mul_f32 v198, v198, v70
    v_mul_f32 v199, v199, v71
    v_mul_f32 v200, v200, v72
    v_mul_f32 v201, v201, v73
    v_mul_f32 v202, v202, v74
    v_mul_f32 v203, v203, v75
    v_mfma_f32_32x32x16_bf16 v[160:175], v[28:31], v[4:7], v[160:175]
    v_mul_f32 v204, v204, v76
    v_mul_f32 v205, v205, v77
    v_mul_f32 v206, v206, v78
    v_mul_f32 v207, v207, v79
    v_cvt_pk_bf16_f32 v96, v192, v193
    v_cvt_pk_bf16_f32 v97, v194, v195
    v_mfma_f32_32x32x16_bf16 v[176:191], v[20:23], v[4:7], v[176:191]
    v_xor_b32 v24, 0x80008000, v24
    v_xor_b32 v25, 0x80008000, v25
    v_xor_b32 v26, 0x80008000, v26
    v_xor_b32 v27, 0x80008000, v27
    v_cvt_pk_bf16_f32 v98, v196, v197
    v_cvt_pk_bf16_f32 v99, v198, v199
    v_cvt_pk_bf16_f32 v100, v200, v201
    v_cvt_pk_bf16_f32 v101, v202, v203
    v_cvt_pk_bf16_f32 v102, v204, v205
    v_cvt_pk_bf16_f32 v103, v206, v207
    v_mfma_f32_32x32x16_bf16 v[160:175], v[16:19], v[120:123], v[160:175]
    v_xor_b32 v28, 0x80008000, v28
    v_xor_b32 v29, 0x80008000, v29
    v_xor_b32 v30, 0x80008000, v30
    v_xor_b32 v31, 0x80008000, v31
    v_mul_f32 v208, v208, v64
    v_mul_f32 v209, v209, v65
    v_mul_f32 v210, v210, v66
    v_mul_f32 v211, v211, v67
    v_mul_f32 v212, v212, v68
    v_mul_f32 v213, v213, v69
    v_mfma_f32_32x32x16_bf16 v[160:175], v[20:23], v[124:127], v[160:175]
    v_mul_f32 v214, v214, v70
    v_mul_f32 v215, v215, v71
    v_mul_f32 v216, v216, v72
    v_mul_f32 v217, v217, v73
    v_mul_f32 v218, v218, v74
    v_mfma_f32_32x32x16_bf16 v[176:191], v[24:27], v[120:123], v[176:191]
    v_mul_f32 v219, v219, v75
    v_mul_f32 v220, v220, v76
    v_mul_f32 v221, v221, v77
    v_mul_f32 v222, v222, v78
    v_mul_f32 v223, v223, v79
    ds_read_b128 v[64:67], v114 offset:384
    ds_read_b128 v[68:71], v114 offset:416
    ds_read_b128 v[72:75], v114 offset:448
    ds_read_b128 v[76:79], v114 offset:480
    v_mfma_f32_32x32x16_bf16 v[176:191], v[28:31], v[124:127], v[176:191]
    v_cvt_pk_bf16_f32 v16, v208, v209
    v_cvt_pk_bf16_f32 v17, v210, v211
    v_cvt_pk_bf16_f32 v18, v212, v213
    v_cvt_pk_bf16_f32 v19, v214, v215
    v_cvt_pk_bf16_f32 v20, v216, v217
    v_cvt_pk_bf16_f32 v21, v218, v219
    v_cvt_pk_bf16_f32 v22, v220, v221
    v_cvt_pk_bf16_f32 v23, v222, v223
    s_waitcnt lgkmcnt(0)
    s_nop 1
    v_mfma_f32_32x32x16_bf16 v[192:207], v[40:43], v[16:19], 0
    v_mul_f32 v224, v224, v64
    v_mul_f32 v225, v225, v65
    v_mul_f32 v226, v226, v66
    v_mul_f32 v227, v227, v67
    v_mul_f32 v228, v228, v68
    v_mul_f32 v229, v229, v69
    v_mfma_f32_32x32x16_bf16 v[208:223], v[32:35], v[16:19], 0
    v_mul_f32 v230, v230, v70
    v_mul_f32 v231, v231, v71
    v_mul_f32 v232, v232, v72
    v_mul_f32 v233, v233, v73
    v_mul_f32 v234, v234, v74
    v_mul_f32 v235, v235, v75
    v_mfma_f32_32x32x16_bf16 v[192:207], v[44:47], v[20:23], v[192:207]
    v_mul_f32 v236, v236, v76
    v_mul_f32 v237, v237, v77
    v_mul_f32 v238, v238, v78
    v_mul_f32 v239, v239, v79
    v_cvt_pk_bf16_f32 v120, v224, v225
    v_cvt_pk_bf16_f32 v121, v226, v227
    v_mfma_f32_32x32x16_bf16 v[208:223], v[36:39], v[20:23], v[208:223]
    v_xor_b32 v40, 0x80008000, v40
    v_xor_b32 v41, 0x80008000, v41
    v_xor_b32 v42, 0x80008000, v42
    v_xor_b32 v43, 0x80008000, v43
    v_cvt_pk_bf16_f32 v122, v228, v229
    v_cvt_pk_bf16_f32 v123, v230, v231
    v_cvt_pk_bf16_f32 v124, v232, v233
    v_cvt_pk_bf16_f32 v125, v234, v235
    v_cvt_pk_bf16_f32 v126, v236, v237
    v_cvt_pk_bf16_f32 v127, v238, v239
    v_mfma_f32_32x32x16_bf16 v[192:207], v[32:35], v[96:99], v[192:207]
    v_xor_b32 v44, 0x80008000, v44
    v_xor_b32 v45, 0x80008000, v45
    v_xor_b32 v46, 0x80008000, v46
    v_xor_b32 v47, 0x80008000, v47
    v_mul_f32 v240, v240, v64
    v_mul_f32 v241, v241, v65
    v_mul_f32 v242, v242, v66
    v_mul_f32 v243, v243, v67
    v_mul_f32 v244, v244, v68
    v_mul_f32 v245, v245, v69
    v_mfma_f32_32x32x16_bf16 v[192:207], v[36:39], v[100:103], v[192:207]
    v_mul_f32 v246, v246, v70
    v_mul_f32 v247, v247, v71
    v_mul_f32 v248, v248, v72
    v_mul_f32 v249, v249, v73
    v_mul_f32 v250, v250, v74
    v_mfma_f32_32x32x16_bf16 v[208:223], v[40:43], v[96:99], v[208:223]
    v_mul_f32 v251, v251, v75
    v_mul_f32 v252, v252, v76
    v_mul_f32 v253, v253, v77
    v_mul_f32 v254, v254, v78
    v_mul_f32 v255, v255, v79
    v_mfma_f32_32x32x16_bf16 v[208:223], v[44:47], v[100:103], v[208:223]
    v_cvt_pk_bf16_f32 v32, v240, v241
    v_cvt_pk_bf16_f32 v33, v242, v243
    v_cvt_pk_bf16_f32 v34, v244, v245
    v_cvt_pk_bf16_f32 v35, v246, v247
    v_cvt_pk_bf16_f32 v36, v248, v249
    v_cvt_pk_bf16_f32 v37, v250, v251
    v_cvt_pk_bf16_f32 v38, v252, v253
    v_cvt_pk_bf16_f32 v39, v254, v255
    s_nop 1
    v_mfma_f32_32x32x16_bf16 v[224:239], v[56:59], v[32:35], 0
    v_mfma_f32_32x32x16_bf16 v[240:255], v[48:51], v[32:35], 0
    v_mfma_f32_32x32x16_bf16 v[224:239], v[60:63], v[36:39], v[224:239]
    v_mfma_f32_32x32x16_bf16 v[240:255], v[52:55], v[36:39], v[240:255]
    v_xor_b32 v56, 0x80008000, v56
    v_xor_b32 v57, 0x80008000, v57
    v_xor_b32 v58, 0x80008000, v58
    v_xor_b32 v59, 0x80008000, v59
    v_mfma_f32_32x32x16_bf16 v[224:239], v[48:51], v[120:123], v[224:239]
    v_xor_b32 v60, 0x80008000, v60
    v_xor_b32 v61, 0x80008000, v61
    v_xor_b32 v62, 0x80008000, v62
    v_xor_b32 v63, 0x80008000, v63
    v_mfma_f32_32x32x16_bf16 v[224:239], v[52:55], v[124:127], v[224:239]
    v_mfma_f32_32x32x16_bf16 v[240:255], v[56:59], v[120:123], v[240:255]
    v_mfma_f32_32x32x16_bf16 v[240:255], v[60:63], v[124:127], v[240:255]
    v_and_b32 v112, 31, v117
    v_lshrrev_b32 v113, 5, v117
    v_lshlrev_b32 v112, 4, v112
    v_lshl_add_u32 v125, v113, 18, v112
    s_nop 7
    v_cvt_pk_bf16_f32 v0, v128, v144
    v_cvt_pk_bf16_f32 v1, v160, v176
    v_cvt_pk_bf16_f32 v2, v192, v208
    v_cvt_pk_bf16_f32 v3, v224, v240
    s_add_u32 s65, s62, 0
    buffer_store_dwordx4 v[0:3], v125, s[20:23], s65 offen sc1
    v_cvt_pk_bf16_f32 v4, v129, v145
    v_cvt_pk_bf16_f32 v5, v161, v177
    v_cvt_pk_bf16_f32 v6, v193, v209
    v_cvt_pk_bf16_f32 v7, v225, v241
    s_add_u32 s65, s62, 65536
    buffer_store_dwordx4 v[4:7], v125, s[20:23], s65 offen sc1
    v_cvt_pk_bf16_f32 v8, v130, v146
    v_cvt_pk_bf16_f32 v9, v162, v178
    v_cvt_pk_bf16_f32 v10, v194, v210
    v_cvt_pk_bf16_f32 v11, v226, v242
    s_add_u32 s65, s62, 131072
    buffer_store_dwordx4 v[8:11], v125, s[20:23], s65 offen sc1
    v_cvt_pk_bf16_f32 v12, v131, v147
    v_cvt_pk_bf16_f32 v13, v163, v179
    v_cvt_pk_bf16_f32 v14, v195, v211
    v_cvt_pk_bf16_f32 v15, v227, v243
    s_add_u32 s65, s62, 196608
    buffer_store_dwordx4 v[12:15], v125, s[20:23], s65 offen sc1
    v_cvt_pk_bf16_f32 v16, v132, v148
    v_cvt_pk_bf16_f32 v17, v164, v180
    v_cvt_pk_bf16_f32 v18, v196, v212
    v_cvt_pk_bf16_f32 v19, v228, v244
    s_add_u32 s65, s62, 524288
    buffer_store_dwordx4 v[16:19], v125, s[20:23], s65 offen sc1
    v_cvt_pk_bf16_f32 v20, v133, v149
    v_cvt_pk_bf16_f32 v21, v165, v181
    v_cvt_pk_bf16_f32 v22, v197, v213
    v_cvt_pk_bf16_f32 v23, v229, v245
    s_add_u32 s65, s62, 589824
    buffer_store_dwordx4 v[20:23], v125, s[20:23], s65 offen sc1
    v_cvt_pk_bf16_f32 v24, v134, v150
    v_cvt_pk_bf16_f32 v25, v166, v182
    v_cvt_pk_bf16_f32 v26, v198, v214
    v_cvt_pk_bf16_f32 v27, v230, v246
    s_add_u32 s65, s62, 655360
    buffer_store_dwordx4 v[24:27], v125, s[20:23], s65 offen sc1
    v_cvt_pk_bf16_f32 v28, v135, v151
    v_cvt_pk_bf16_f32 v29, v167, v183
    v_cvt_pk_bf16_f32 v30, v199, v215
    v_cvt_pk_bf16_f32 v31, v231, v247
    s_add_u32 s65, s62, 720896
    buffer_store_dwordx4 v[28:31], v125, s[20:23], s65 offen sc1
    v_cvt_pk_bf16_f32 v32, v136, v152
    v_cvt_pk_bf16_f32 v33, v168, v184
    v_cvt_pk_bf16_f32 v34, v200, v216
    v_cvt_pk_bf16_f32 v35, v232, v248
    s_add_u32 s65, s62, 1048576
    buffer_store_dwordx4 v[32:35], v125, s[20:23], s65 offen sc1
    v_cvt_pk_bf16_f32 v36, v137, v153
    v_cvt_pk_bf16_f32 v37, v169, v185
    v_cvt_pk_bf16_f32 v38, v201, v217
    v_cvt_pk_bf16_f32 v39, v233, v249
    s_add_u32 s65, s62, 1114112
    buffer_store_dwordx4 v[36:39], v125, s[20:23], s65 offen sc1
    v_cvt_pk_bf16_f32 v40, v138, v154
    v_cvt_pk_bf16_f32 v41, v170, v186
    v_cvt_pk_bf16_f32 v42, v202, v218
    v_cvt_pk_bf16_f32 v43, v234, v250
    s_add_u32 s65, s62, 1179648
    buffer_store_dwordx4 v[40:43], v125, s[20:23], s65 offen sc1
    v_cvt_pk_bf16_f32 v44, v139, v155
    v_cvt_pk_bf16_f32 v45, v171, v187
    v_cvt_pk_bf16_f32 v46, v203, v219
    v_cvt_pk_bf16_f32 v47, v235, v251
    s_add_u32 s65, s62, 1245184
    buffer_store_dwordx4 v[44:47], v125, s[20:23], s65 offen sc1
    v_cvt_pk_bf16_f32 v48, v140, v156
    v_cvt_pk_bf16_f32 v49, v172, v188
    v_cvt_pk_bf16_f32 v50, v204, v220
    v_cvt_pk_bf16_f32 v51, v236, v252
    s_add_u32 s65, s62, 1572864
    buffer_store_dwordx4 v[48:51], v125, s[20:23], s65 offen sc1
    v_cvt_pk_bf16_f32 v52, v141, v157
    v_cvt_pk_bf16_f32 v53, v173, v189
    v_cvt_pk_bf16_f32 v54, v205, v221
    v_cvt_pk_bf16_f32 v55, v237, v253
    s_add_u32 s65, s62, 1638400
    buffer_store_dwordx4 v[52:55], v125, s[20:23], s65 offen sc1
    v_cvt_pk_bf16_f32 v56, v142, v158
    v_cvt_pk_bf16_f32 v57, v174, v190
    v_cvt_pk_bf16_f32 v58, v206, v222
    v_cvt_pk_bf16_f32 v59, v238, v254
    s_add_u32 s65, s62, 1703936
    buffer_store_dwordx4 v[56:59], v125, s[20:23], s65 offen sc1
    v_cvt_pk_bf16_f32 v60, v143, v159
    v_cvt_pk_bf16_f32 v61, v175, v191
    v_cvt_pk_bf16_f32 v62, v207, v223
    v_cvt_pk_bf16_f32 v63, v239, v255
    s_add_u32 s65, s62, 1769472
    buffer_store_dwordx4 v[60:63], v125, s[20:23], s65 offen sc1
    v_mov_b32 v64, 150532
    v_mov_b32 v65, 1
    s_mov_b64 exec, 1
    ds_add_u32 v64, v65
    s_mov_b64 exec, -1
    s_branch PHASE2
END:
    s_endpgm
.section .rodata,"a"
.p2align 6
.amdhsa_kernel recurrent_scan__spectral_fnet__glu_gated_glu__prompt_kernel
  .amdhsa_next_free_vgpr 256
  .amdhsa_next_free_sgpr 102
  .amdhsa_accum_offset 256
  .amdhsa_group_segment_fixed_size 0
  .amdhsa_kernarg_size 96
  .amdhsa_user_sgpr_count 2
  .amdhsa_user_sgpr_kernarg_segment_ptr 1
  .amdhsa_system_sgpr_workgroup_id_x 1
.end_amdhsa_kernel
```
